```python
import torch

def _softmax(x, axis=-1):
    return torch.softmax(x, dim=axis)
def _gelu(x):
    return torch.nn.functional.gelu(x, approximate="tanh")
def _silu(x):
    return torch.nn.functional.silu(x)
def _sigmoid(x):
    return torch.sigmoid(x)
def _layernorm(x, axis=-1, eps=1e-5):
    m = x.mean(dim=axis, keepdim=True)
    v = x.var(dim=axis, keepdim=True, unbiased=False)
    return (x - m) / torch.sqrt(v + eps)
def _scatter_add(tgt, idx, src, axis=0):
    return tgt.clone().index_add_(axis, idx, src)
def _segment_sum(src, seg, n):
    out = torch.zeros((n,) + src.shape[1:], dtype=src.dtype)
    return out.index_add_(0, seg, src)
def _pad(x, pw):
    flat = tuple(v for pair in reversed(pw) for v in pair)
    return torch.nn.functional.pad(x, flat)

kernel_name = 'sequential_preLN__sliding_block__swiglu_ffn__prompt'

def setup_inputs():

    _w = (lambda a: (lambda t: t.to(torch.bfloat16) if t.is_floating_point() else t)(torch.as_tensor(a)))
    def _A_setup():
        B, S, D = 1, 2048, 448
        return {
            "x": _w((lambda *s: torch.randn(*s, dtype=torch.bfloat16) * 0.05)(B, S, D)),
            "wqkv": _w((lambda *s: torch.randn(*s, dtype=torch.bfloat16) * 0.05)(D, 3 * D)),
            "wo": _w((lambda *s: torch.randn(*s, dtype=torch.bfloat16) * 0.05)(D, D)),
        }
    _A_in = _A_setup()

    def _B_setup():
        B, S, D, F = 1, 2048, 448, 1792
        return {
            "x": _w((lambda *s: torch.randn(*s, dtype=torch.bfloat16) * 0.05)(B, S, D)),
            "w_gate": _w((lambda *s: torch.randn(*s, dtype=torch.bfloat16) * 0.05)(D, F)),
            "w_up": _w((lambda *s: torch.randn(*s, dtype=torch.bfloat16) * 0.05)(D, F)),
            "w_down": _w((lambda *s: torch.randn(*s, dtype=torch.bfloat16) * 0.05)(F, D)),
        }
    _B_in = _B_setup()

    return {
        "A_x": _A_in["x"],
        "A_wqkv": _A_in["wqkv"],
        "A_wo": _A_in["wo"],
        "B_x": _B_in["x"],
        "B_w_gate": _B_in["w_gate"],
        "B_w_up": _B_in["w_up"],
        "B_w_down": _B_in["w_down"],
    }

def reference(A_x, A_wqkv, A_wo, B_x, B_w_gate, B_w_up, B_w_down):
    def _A_ref(x, wqkv, wo):
        B, S, D = x.shape
        H = 16; Dh = D // H; W = 256
        qkv = (lambda x, *d: x.permute(*d))((x @ wqkv).reshape(B, S, 3, H, Dh), 2, 0, 3, 1, 4)
        q, k, v = qkv[0], qkv[1], qkv[2]
        scores = torch.einsum("bhqd,bhkd->bhqk", q, k) * (Dh ** -0.5)
        idx = torch.arange(S)
        mask = (idx[:, None] - idx[None, :] >= 0) & (idx[:, None] - idx[None, :] < W)
        scores = torch.where(mask[None, None], scores, -1e9)
        p = _softmax(scores, axis=-1)
        o = torch.einsum("bhqk,bhkd->bhqd", p, v)
        return (lambda x, *d: x.permute(*d))(o, 0, 2, 1, 3).reshape(B, S, D) @ wo

    def _B_ref(x, w_gate, w_up, w_down):
        g = _silu(x @ w_gate)
        u = x @ w_up
        return (g * u) @ w_down

    x = A_x
    h = x + _A_ref(_layernorm(x, axis=-1), A_wqkv, A_wo)
    h2 = h + _B_ref(_layernorm(h, axis=-1), B_w_gate, B_w_up, B_w_down)
    return h2
```

```asm
; @launch kernel=ka_kernel grid=(256,1,1) block=(512,1,1) lds=155648
; @launch kernel=kb_kernel grid=(256,1,1) block=(512,1,1) lds=163840
.amdgcn_target "amdgcn-amd-amdhsa--gfx950"
.text
.globl ka_kernel
.p2align 8
.type ka_kernel,@function
ka_kernel:
    s_cmp_ge_u32 s2, 256
    s_cbranch_scc1 L_ka_end
    s_load_dwordx16 s[4:19], s[0:1], 0
    s_load_dwordx4 s[20:23], s[0:1], 64
    v_and_b32 v1, 63, v0
    v_lshrrev_b32 v2, 6, v0
    s_and_b32 s25, s2, 7
    v_readfirstlane_b32 s24, v2
    s_lshr_b32 s26, s2, 3
    s_mul_hi_u32 s92, s26, 613566757
    s_mul_i32 s93, s92, 7
    s_sub_u32 s89, s26, s93
    s_lshl_b32 s88, s25, 2
    s_add_u32 s88, s88, s92
    s_cmp_ge_u32 s26, 28
    s_cbranch_scc1 L_ka_spare
    s_lshr_b32 s76, s92, 1
    s_mul_i32 s76, s76, 3
    v_add_u32 v9, 0, v1
    v_mul_u32_u24 v10, 2731, v9
    v_lshrrev_b32 v10, 16, v10
    v_mul_u32_u24 v11, 24, v10
    v_sub_u32 v11, v9, v11
    v_lshrrev_b32 v12, 2, v11
    v_bfe_u32 v13, v10, 1, 1
    v_xor_b32 v12, v12, v13
    v_and_b32 v11, 3, v11
    v_lshlrev_b32 v11, 4, v11
    v_lshl_add_u32 v11, v12, 6, v11
    v_mul_u32_u24 v10, 2688, v10
    v_add_u32 v16, v10, v11
    v_add_u32 v9, 64, v1
    v_mul_u32_u24 v10, 2731, v9
    v_lshrrev_b32 v10, 16, v10
    v_mul_u32_u24 v11, 24, v10
    v_sub_u32 v11, v9, v11
    v_lshrrev_b32 v12, 2, v11
    v_bfe_u32 v13, v10, 1, 1
    v_xor_b32 v12, v12, v13
    v_and_b32 v11, 3, v11
    v_lshlrev_b32 v11, 4, v11
    v_lshl_add_u32 v11, v12, 6, v11
    v_mul_u32_u24 v10, 2688, v10
    v_add_u32 v17, v10, v11
    v_add_u32 v9, 128, v1
    v_mul_u32_u24 v10, 2731, v9
    v_lshrrev_b32 v10, 16, v10
    v_mul_u32_u24 v11, 24, v10
    v_sub_u32 v11, v9, v11
    v_lshrrev_b32 v12, 2, v11
    v_bfe_u32 v13, v10, 1, 1
    v_xor_b32 v12, v12, v13
    v_and_b32 v11, 3, v11
    v_lshlrev_b32 v11, 4, v11
    v_lshl_add_u32 v11, v12, 6, v11
    v_mul_u32_u24 v10, 2688, v10
    v_add_u32 v18, v10, v11
    s_mul_i32 s40, s89, 384
    s_and_b32 s43, s24, 3
    s_mul_i32 s44, s43, 43008
    s_add_u32 s44, s44, s40
    s_mul_i32 s45, s43, 6144
    s_add_u32 s45, s45, 57344
    s_add_u32 s66, s76, 0
    s_sub_u32 s100, s66, 7
    s_cmp_ge_u32 s66, 7
    s_cselect_b32 s66, s100, s66
    s_add_u32 s67, s76, 1
    s_sub_u32 s100, s67, 7
    s_cmp_ge_u32 s67, 7
    s_cselect_b32 s67, s100, s67
    s_add_u32 s68, s76, 2
    s_sub_u32 s100, s68, 7
    s_cmp_ge_u32 s68, 7
    s_cselect_b32 s68, s100, s68
    s_add_u32 s69, s76, 3
    s_sub_u32 s100, s69, 7
    s_cmp_ge_u32 s69, 7
    s_cselect_b32 s69, s100, s69
    s_add_u32 s70, s76, 4
    s_sub_u32 s100, s70, 7
    s_cmp_ge_u32 s70, 7
    s_cselect_b32 s70, s100, s70
    s_add_u32 s71, s76, 5
    s_sub_u32 s100, s71, 7
    s_cmp_ge_u32 s71, 7
    s_cselect_b32 s71, s100, s71
    s_add_u32 s72, s76, 6
    s_sub_u32 s100, s72, 7
    s_cmp_ge_u32 s72, 7
    s_cselect_b32 s72, s100, s72
    s_mul_i32 s41, s24, 21504
    s_add_u32 s41, s41, s40
    s_mul_i32 s42, s24, 3072
    s_add_u32 s42, s42, 57344
    v_lshrrev_b32 v5, 3, v1
    s_add_u32 s38, s24, s89
    s_and_b32 s38, s38, 7
    s_lshl_b32 s38, s38, 3
    v_add_u32 v5, s38, v5
    v_mul_u32_u24 v6, 896, v5
    v_and_b32 v7, 7, v1
    v_lshl_add_u32 v6, v7, 4, v6
    s_mul_i32 s38, s88, 57344
    v_bfe_u32 v8, v5, 1, 3
    v_xor_b32 v8, v8, v7
    v_lshlrev_b32 v8, 4, v8
    v_lshl_add_u32 v8, v5, 7, v8
    s_lshl_b32 s78, s66, 7
    s_add_u32 s78, s78, s38
    s_lshl_b32 s79, s67, 7
    s_add_u32 s79, s79, s38
    s_lshl_b32 s80, s68, 7
    s_add_u32 s80, s80, s38
    s_lshl_b32 s81, s69, 7
    s_add_u32 s81, s81, s38
    s_lshl_b32 s82, s70, 7
    s_add_u32 s82, s82, s38
    s_lshl_b32 s83, s71, 7
    s_add_u32 s83, s83, s38
    s_lshl_b32 s84, s72, 7
    s_add_u32 s84, s84, s38
    v_mov_b32 v19, 0x3f803f80
    s_mov_b32 s39, 0xffff0000
    v_mov_b32 v20, 0
    v_mov_b32 v21, 0
    v_mov_b32 v22, 0
    v_mov_b32 v23, 0
    s_waitcnt lgkmcnt(0)
    s_mov_b32 s48, s4
    s_mov_b32 s49, s5
    s_and_b32 s49, s49, 0xffff
    s_mov_b32 s50, 1835008
    s_mov_b32 s51, 0x00020000
    buffer_load_dwordx4 v[32:35], v6, s[48:51], s78 offen
    buffer_load_dwordx4 v[36:39], v6, s[48:51], s79 offen
    buffer_load_dwordx4 v[40:43], v6, s[48:51], s80 offen
    buffer_load_dwordx4 v[44:47], v6, s[48:51], s81 offen
    buffer_load_dwordx4 v[48:51], v6, s[48:51], s82 offen
    buffer_load_dwordx4 v[52:55], v6, s[48:51], s83 offen
    buffer_load_dwordx4 v[56:59], v6, s[48:51], s84 offen
    s_mov_b32 s52, s6
    s_mov_b32 s53, s7
    s_and_b32 s53, s53, 0xffff
    s_mov_b32 s54, 1204224
    s_mov_b32 s55, 0x00020000
    s_waitcnt vmcnt(6)
    v_dot2c_f32_bf16 v20, v32, v19
    v_dot2c_f32_bf16 v22, v32, v32
    v_dot2c_f32_bf16 v21, v33, v19
    v_dot2c_f32_bf16 v23, v33, v33
    v_dot2c_f32_bf16 v20, v34, v19
    v_dot2c_f32_bf16 v22, v34, v34
    v_dot2c_f32_bf16 v21, v35, v19
    v_dot2c_f32_bf16 v23, v35, v35
    s_waitcnt vmcnt(5)
    v_dot2c_f32_bf16 v20, v36, v19
    v_dot2c_f32_bf16 v22, v36, v36
    v_dot2c_f32_bf16 v21, v37, v19
    v_dot2c_f32_bf16 v23, v37, v37
    v_dot2c_f32_bf16 v20, v38, v19
    v_dot2c_f32_bf16 v22, v38, v38
    v_dot2c_f32_bf16 v21, v39, v19
    v_dot2c_f32_bf16 v23, v39, v39
    s_waitcnt vmcnt(4)
    v_dot2c_f32_bf16 v20, v40, v19
    v_dot2c_f32_bf16 v22, v40, v40
    v_dot2c_f32_bf16 v21, v41, v19
    v_dot2c_f32_bf16 v23, v41, v41
    v_dot2c_f32_bf16 v20, v42, v19
    v_dot2c_f32_bf16 v22, v42, v42
    v_dot2c_f32_bf16 v21, v43, v19
    v_dot2c_f32_bf16 v23, v43, v43
    s_waitcnt vmcnt(3)
    v_dot2c_f32_bf16 v20, v44, v19
    v_dot2c_f32_bf16 v22, v44, v44
    v_dot2c_f32_bf16 v21, v45, v19
    v_dot2c_f32_bf16 v23, v45, v45
    v_dot2c_f32_bf16 v20, v46, v19
    v_dot2c_f32_bf16 v22, v46, v46
    v_dot2c_f32_bf16 v21, v47, v19
    v_dot2c_f32_bf16 v23, v47, v47
    s_waitcnt vmcnt(2)
    v_dot2c_f32_bf16 v20, v48, v19
    v_dot2c_f32_bf16 v22, v48, v48
    v_dot2c_f32_bf16 v21, v49, v19
    v_dot2c_f32_bf16 v23, v49, v49
    v_dot2c_f32_bf16 v20, v50, v19
    v_dot2c_f32_bf16 v22, v50, v50
    v_dot2c_f32_bf16 v21, v51, v19
    v_dot2c_f32_bf16 v23, v51, v51
    s_waitcnt vmcnt(1)
    v_dot2c_f32_bf16 v20, v52, v19
    v_dot2c_f32_bf16 v22, v52, v52
    v_dot2c_f32_bf16 v21, v53, v19
    v_dot2c_f32_bf16 v23, v53, v53
    v_dot2c_f32_bf16 v20, v54, v19
    v_dot2c_f32_bf16 v22, v54, v54
    v_dot2c_f32_bf16 v21, v55, v19
    v_dot2c_f32_bf16 v23, v55, v55
    s_waitcnt vmcnt(0)
    v_dot2c_f32_bf16 v20, v56, v19
    v_dot2c_f32_bf16 v22, v56, v56
    v_dot2c_f32_bf16 v21, v57, v19
    v_dot2c_f32_bf16 v23, v57, v57
    v_dot2c_f32_bf16 v20, v58, v19
    v_dot2c_f32_bf16 v22, v58, v58
    v_dot2c_f32_bf16 v21, v59, v19
    v_dot2c_f32_bf16 v23, v59, v59
    s_barrier
    s_cmp_lt_u32 s24, 4
    s_cbranch_scc1 L_ka_nw01
    s_mul_i32 s47, s66, 172032
    s_add_u32 s47, s47, s44
    s_add_u32 s46, s47, 21504
    s_add_u32 m0, s45, 0
    s_nop 0
    buffer_load_dwordx4 v16, s[52:55], s47 offen lds
    s_add_u32 m0, s45, 1024
    s_nop 0
    buffer_load_dwordx4 v17, s[52:55], s47 offen lds
    s_add_u32 m0, s45, 2048
    s_nop 0
    buffer_load_dwordx4 v18, s[52:55], s47 offen lds
    s_add_u32 m0, s45, 3072
    s_nop 0
    buffer_load_dwordx4 v16, s[52:55], s46 offen lds
    s_add_u32 m0, s45, 4096
    s_nop 0
    buffer_load_dwordx4 v17, s[52:55], s46 offen lds
    s_add_u32 m0, s45, 5120
    s_nop 0
    buffer_load_dwordx4 v18, s[52:55], s46 offen lds
L_ka_nw01:
    v_add_f32 v20, v20, v21
    v_add_f32 v22, v22, v23
    s_nop 1
    v_add_f32_dpp v20, v20, v20 quad_perm:[1,0,3,2] row_mask:0xf bank_mask:0xf
    v_add_f32_dpp v22, v22, v22 quad_perm:[1,0,3,2] row_mask:0xf bank_mask:0xf
    s_nop 1
    v_add_f32_dpp v20, v20, v20 quad_perm:[2,3,0,1] row_mask:0xf bank_mask:0xf
    v_add_f32_dpp v22, v22, v22 quad_perm:[2,3,0,1] row_mask:0xf bank_mask:0xf
    s_nop 1
    v_add_f32_dpp v20, v20, v20 row_half_mirror row_mask:0xf bank_mask:0xf
    v_add_f32_dpp v22, v22, v22 row_half_mirror row_mask:0xf bank_mask:0xf
    v_mul_f32 v20, 991054117, v20
    v_mul_f32 v22, 991054117, v22
    v_fma_f32 v22, -v20, v20, v22
    v_max_f32 v22, 0, v22
    v_add_f32 v22, 925353388, v22
    v_rsq_f32 v22, v22
    s_nop 0
    v_mul_f32 v20, v20, v22
    v_sub_f32 v20, 0, v20
    v_lshlrev_b32 v96, 16, v32
    v_and_b32 v97, s39, v32
    v_lshlrev_b32 v98, 16, v33
    v_and_b32 v99, s39, v33
    v_lshlrev_b32 v100, 16, v34
    v_and_b32 v101, s39, v34
    v_lshlrev_b32 v102, 16, v35
    v_and_b32 v103, s39, v35
    v_pk_fma_f32 v[96:97], v[96:97], v[22:23], v[20:21] op_sel_hi:[1,0,0]
    v_pk_fma_f32 v[98:99], v[98:99], v[22:23], v[20:21] op_sel_hi:[1,0,0]
    v_pk_fma_f32 v[100:101], v[100:101], v[22:23], v[20:21] op_sel_hi:[1,0,0]
    v_pk_fma_f32 v[102:103], v[102:103], v[22:23], v[20:21] op_sel_hi:[1,0,0]
    v_cvt_pk_bf16_f32 v32, v96, v97
    v_cvt_pk_bf16_f32 v33, v98, v99
    v_cvt_pk_bf16_f32 v34, v100, v101
    v_cvt_pk_bf16_f32 v35, v102, v103
    ds_write_b128 v8, v[32:35] offset:0
    v_lshlrev_b32 v104, 16, v36
    v_and_b32 v105, s39, v36
    v_lshlrev_b32 v106, 16, v37
    v_and_b32 v107, s39, v37
    v_lshlrev_b32 v108, 16, v38
    v_and_b32 v109, s39, v38
    v_lshlrev_b32 v110, 16, v39
    v_and_b32 v111, s39, v39
    v_pk_fma_f32 v[104:105], v[104:105], v[22:23], v[20:21] op_sel_hi:[1,0,0]
    v_pk_fma_f32 v[106:107], v[106:107], v[22:23], v[20:21] op_sel_hi:[1,0,0]
    v_pk_fma_f32 v[108:109], v[108:109], v[22:23], v[20:21] op_sel_hi:[1,0,0]
    v_pk_fma_f32 v[110:111], v[110:111], v[22:23], v[20:21] op_sel_hi:[1,0,0]
    v_cvt_pk_bf16_f32 v36, v104, v105
    v_cvt_pk_bf16_f32 v37, v106, v107
    v_cvt_pk_bf16_f32 v38, v108, v109
    v_cvt_pk_bf16_f32 v39, v110, v111
    ds_write_b128 v8, v[36:39] offset:8192
    v_lshlrev_b32 v96, 16, v40
    v_and_b32 v97, s39, v40
    v_lshlrev_b32 v98, 16, v41
    v_and_b32 v99, s39, v41
    v_lshlrev_b32 v100, 16, v42
    v_and_b32 v101, s39, v42
    v_lshlrev_b32 v102, 16, v43
    v_and_b32 v103, s39, v43
    v_pk_fma_f32 v[96:97], v[96:97], v[22:23], v[20:21] op_sel_hi:[1,0,0]
    v_pk_fma_f32 v[98:99], v[98:99], v[22:23], v[20:21] op_sel_hi:[1,0,0]
    v_pk_fma_f32 v[100:101], v[100:101], v[22:23], v[20:21] op_sel_hi:[1,0,0]
    v_pk_fma_f32 v[102:103], v[102:103], v[22:23], v[20:21] op_sel_hi:[1,0,0]
    v_cvt_pk_bf16_f32 v40, v96, v97
    v_cvt_pk_bf16_f32 v41, v98, v99
    v_cvt_pk_bf16_f32 v42, v100, v101
    v_cvt_pk_bf16_f32 v43, v102, v103
    ds_write_b128 v8, v[40:43] offset:16384
    v_lshlrev_b32 v104, 16, v44
    v_and_b32 v105, s39, v44
    v_lshlrev_b32 v106, 16, v45
    v_and_b32 v107, s39, v45
    v_lshlrev_b32 v108, 16, v46
    v_and_b32 v109, s39, v46
    v_lshlrev_b32 v110, 16, v47
    v_and_b32 v111, s39, v47
    v_pk_fma_f32 v[104:105], v[104:105], v[22:23], v[20:21] op_sel_hi:[1,0,0]
    v_pk_fma_f32 v[106:107], v[106:107], v[22:23], v[20:21] op_sel_hi:[1,0,0]
    v_pk_fma_f32 v[108:109], v[108:109], v[22:23], v[20:21] op_sel_hi:[1,0,0]
    v_pk_fma_f32 v[110:111], v[110:111], v[22:23], v[20:21] op_sel_hi:[1,0,0]
    v_cvt_pk_bf16_f32 v44, v104, v105
    v_cvt_pk_bf16_f32 v45, v106, v107
    v_cvt_pk_bf16_f32 v46, v108, v109
    v_cvt_pk_bf16_f32 v47, v110, v111
    ds_write_b128 v8, v[44:47] offset:24576
    v_lshlrev_b32 v96, 16, v48
    v_and_b32 v97, s39, v48
    v_lshlrev_b32 v98, 16, v49
    v_and_b32 v99, s39, v49
    v_lshlrev_b32 v100, 16, v50
    v_and_b32 v101, s39, v50
    v_lshlrev_b32 v102, 16, v51
    v_and_b32 v103, s39, v51
    v_pk_fma_f32 v[96:97], v[96:97], v[22:23], v[20:21] op_sel_hi:[1,0,0]
    v_pk_fma_f32 v[98:99], v[98:99], v[22:23], v[20:21] op_sel_hi:[1,0,0]
    v_pk_fma_f32 v[100:101], v[100:101], v[22:23], v[20:21] op_sel_hi:[1,0,0]
    v_pk_fma_f32 v[102:103], v[102:103], v[22:23], v[20:21] op_sel_hi:[1,0,0]
    v_cvt_pk_bf16_f32 v48, v96, v97
    v_cvt_pk_bf16_f32 v49, v98, v99
    v_cvt_pk_bf16_f32 v50, v100, v101
    v_cvt_pk_bf16_f32 v51, v102, v103
    ds_write_b128 v8, v[48:51] offset:32768
    v_lshlrev_b32 v104, 16, v52
    v_and_b32 v105, s39, v52
    v_lshlrev_b32 v106, 16, v53
    v_and_b32 v107, s39, v53
    v_lshlrev_b32 v108, 16, v54
    v_and_b32 v109, s39, v54
    v_lshlrev_b32 v110, 16, v55
    v_and_b32 v111, s39, v55
    v_pk_fma_f32 v[104:105], v[104:105], v[22:23], v[20:21] op_sel_hi:[1,0,0]
    v_pk_fma_f32 v[106:107], v[106:107], v[22:23], v[20:21] op_sel_hi:[1,0,0]
    v_pk_fma_f32 v[108:109], v[108:109], v[22:23], v[20:21] op_sel_hi:[1,0,0]
    v_pk_fma_f32 v[110:111], v[110:111], v[22:23], v[20:21] op_sel_hi:[1,0,0]
    v_cvt_pk_bf16_f32 v52, v104, v105
    v_cvt_pk_bf16_f32 v53, v106, v107
    v_cvt_pk_bf16_f32 v54, v108, v109
    v_cvt_pk_bf16_f32 v55, v110, v111
    ds_write_b128 v8, v[52:55] offset:40960
    v_lshlrev_b32 v96, 16, v56
    v_and_b32 v97, s39, v56
    v_lshlrev_b32 v98, 16, v57
    v_and_b32 v99, s39, v57
    v_lshlrev_b32 v100, 16, v58
    v_and_b32 v101, s39, v58
    v_lshlrev_b32 v102, 16, v59
    v_and_b32 v103, s39, v59
    v_pk_fma_f32 v[96:97], v[96:97], v[22:23], v[20:21] op_sel_hi:[1,0,0]
    v_pk_fma_f32 v[98:99], v[98:99], v[22:23], v[20:21] op_sel_hi:[1,0,0]
    v_pk_fma_f32 v[100:101], v[100:101], v[22:23], v[20:21] op_sel_hi:[1,0,0]
    v_pk_fma_f32 v[102:103], v[102:103], v[22:23], v[20:21] op_sel_hi:[1,0,0]
    v_cvt_pk_bf16_f32 v56, v96, v97
    v_cvt_pk_bf16_f32 v57, v98, v99
    v_cvt_pk_bf16_f32 v58, v100, v101
    v_cvt_pk_bf16_f32 v59, v102, v103
    ds_write_b128 v8, v[56:59] offset:49152
    s_cmp_ge_u32 s24, 4
    s_cbranch_scc1 L_ka_C
    s_waitcnt lgkmcnt(0)
    s_barrier
    s_mul_i32 s47, s68, 172032
    s_add_u32 s47, s47, s44
    s_add_u32 s46, s47, 21504
    s_add_u32 m0, s45, 49152
    s_nop 0
    buffer_load_dwordx4 v16, s[52:55], s47 offen lds
    s_add_u32 m0, s45, 50176
    s_nop 0
    buffer_load_dwordx4 v17, s[52:55], s47 offen lds
    s_add_u32 m0, s45, 51200
    s_nop 0
    buffer_load_dwordx4 v18, s[52:55], s47 offen lds
    s_add_u32 m0, s45, 52224
    s_nop 0
    buffer_load_dwordx4 v16, s[52:55], s46 offen lds
    s_add_u32 m0, s45, 53248
    s_nop 0
    buffer_load_dwordx4 v17, s[52:55], s46 offen lds
    s_add_u32 m0, s45, 54272
    s_nop 0
    buffer_load_dwordx4 v18, s[52:55], s46 offen lds
    s_barrier
    s_mul_i32 s47, s69, 172032
    s_add_u32 s47, s47, s44
    s_add_u32 s46, s47, 21504
    s_add_u32 m0, s45, 73728
    s_nop 0
    buffer_load_dwordx4 v16, s[52:55], s47 offen lds
    s_add_u32 m0, s45, 74752
    s_nop 0
    buffer_load_dwordx4 v17, s[52:55], s47 offen lds
    s_add_u32 m0, s45, 75776
    s_nop 0
    buffer_load_dwordx4 v18, s[52:55], s47 offen lds
    s_add_u32 m0, s45, 76800
    s_nop 0
    buffer_load_dwordx4 v16, s[52:55], s46 offen lds
    s_add_u32 m0, s45, 77824
    s_nop 0
    buffer_load_dwordx4 v17, s[52:55], s46 offen lds
    s_add_u32 m0, s45, 78848
    s_nop 0
    buffer_load_dwordx4 v18, s[52:55], s46 offen lds
    s_waitcnt vmcnt(6)
    s_barrier
    s_mul_i32 s47, s70, 172032
    s_add_u32 s47, s47, s44
    s_add_u32 s46, s47, 21504
    s_add_u32 m0, s45, 0
    s_nop 0
    buffer_load_dwordx4 v16, s[52:55], s47 offen lds
    s_add_u32 m0, s45, 1024
    s_nop 0
    buffer_load_dwordx4 v17, s[52:55], s47 offen lds
    s_add_u32 m0, s45, 2048
    s_nop 0
    buffer_load_dwordx4 v18, s[52:55], s47 offen lds
    s_add_u32 m0, s45, 3072
    s_nop 0
    buffer_load_dwordx4 v16, s[52:55], s46 offen lds
    s_add_u32 m0, s45, 4096
    s_nop 0
    buffer_load_dwordx4 v17, s[52:55], s46 offen lds
    s_add_u32 m0, s45, 5120
    s_nop 0
    buffer_load_dwordx4 v18, s[52:55], s46 offen lds
    s_waitcnt vmcnt(6)
    s_barrier
    s_mul_i32 s47, s71, 172032
    s_add_u32 s47, s47, s44
    s_add_u32 s46, s47, 21504
    s_add_u32 m0, s45, 24576
    s_nop 0
    buffer_load_dwordx4 v16, s[52:55], s47 offen lds
    s_add_u32 m0, s45, 25600
    s_nop 0
    buffer_load_dwordx4 v17, s[52:55], s47 offen lds
    s_add_u32 m0, s45, 26624
    s_nop 0
    buffer_load_dwordx4 v18, s[52:55], s47 offen lds
    s_add_u32 m0, s45, 27648
    s_nop 0
    buffer_load_dwordx4 v16, s[52:55], s46 offen lds
    s_add_u32 m0, s45, 28672
    s_nop 0
    buffer_load_dwordx4 v17, s[52:55], s46 offen lds
    s_add_u32 m0, s45, 29696
    s_nop 0
    buffer_load_dwordx4 v18, s[52:55], s46 offen lds
    s_waitcnt vmcnt(6)
    s_barrier
    s_mul_i32 s47, s72, 172032
    s_add_u32 s47, s47, s44
    s_add_u32 s46, s47, 21504
    s_add_u32 m0, s45, 49152
    s_nop 0
    buffer_load_dwordx4 v16, s[52:55], s47 offen lds
    s_add_u32 m0, s45, 50176
    s_nop 0
    buffer_load_dwordx4 v17, s[52:55], s47 offen lds
    s_add_u32 m0, s45, 51200
    s_nop 0
    buffer_load_dwordx4 v18, s[52:55], s47 offen lds
    s_add_u32 m0, s45, 52224
    s_nop 0
    buffer_load_dwordx4 v16, s[52:55], s46 offen lds
    s_add_u32 m0, s45, 53248
    s_nop 0
    buffer_load_dwordx4 v17, s[52:55], s46 offen lds
    s_add_u32 m0, s45, 54272
    s_nop 0
    buffer_load_dwordx4 v18, s[52:55], s46 offen lds
    s_add_u32 s56, s22, 10485760
    s_addc_u32 s57, s23, 0
    s_and_b32 s57, s57, 0xffff
    s_mov_b32 s58, 7340032
    s_mov_b32 s59, 0x00020000
    v_lshlrev_b32 v9, 7, v1
    v_mov_b32 v10, 0x40000000
    v_cmp_gt_u32 vcc, 48, v1
    s_lshl_b32 s60, s88, 1
    s_lshr_b32 s61, s43, 1
    v_cndmask_b32 v9, v10, v9, vcc
    s_add_u32 s60, s60, s61
    s_mul_i32 s60, s60, 114688
    s_mul_i32 s61, s89, 12288
    s_add_u32 s60, s60, s61
    s_and_b32 s61, s43, 1
    s_mul_i32 s61, s61, 6144
    s_add_u32 s60, s60, s61
    buffer_load_dword v30, v9, s[56:59], s60 offen sc1
    s_waitcnt vmcnt(7)
    s_barrier
    s_waitcnt vmcnt(1)
    s_barrier
    s_endpgm
L_ka_C:
    s_mul_i32 s47, s67, 172032
    s_add_u32 s47, s47, s44
    s_add_u32 s46, s47, 21504
    s_add_u32 m0, s45, 24576
    s_nop 0
    buffer_load_dwordx4 v16, s[52:55], s47 offen lds
    s_add_u32 m0, s45, 25600
    s_nop 0
    buffer_load_dwordx4 v17, s[52:55], s47 offen lds
    s_add_u32 m0, s45, 26624
    s_nop 0
    buffer_load_dwordx4 v18, s[52:55], s47 offen lds
    s_add_u32 m0, s45, 27648
    s_nop 0
    buffer_load_dwordx4 v16, s[52:55], s46 offen lds
    s_add_u32 m0, s45, 28672
    s_nop 0
    buffer_load_dwordx4 v17, s[52:55], s46 offen lds
    s_add_u32 m0, s45, 29696
    s_nop 0
    buffer_load_dwordx4 v18, s[52:55], s46 offen lds
    s_and_b32 s36, s43, 1
    s_lshr_b32 s37, s43, 1
    s_add_u32 s56, s22, 10485760
    s_addc_u32 s57, s23, 0
    s_and_b32 s57, s57, 0xffff
    s_mov_b32 s58, 7340032
    s_mov_b32 s59, 0x00020000
    v_and_b32 v3, 31, v1
    s_lshl_b32 s60, s36, 5
    v_add_u32 v3, s60, v3
    v_lshrrev_b32 v4, 5, v1
    v_bfe_u32 v5, v3, 1, 3
    v_xor_b32 v5, v5, v4
    v_lshlrev_b32 v5, 4, v5
    v_lshl_add_u32 v10, v3, 7, v5
    v_xor_b32 v11, 32, v10
    v_xor_b32 v12, 64, v10
    v_xor_b32 v13, 96, v10
    v_bfe_u32 v5, v1, 2, 2
    v_lshl_add_u32 v6, v4, 3, v5
    v_mul_u32_u24 v6, 384, v6
    v_bfe_u32 v7, v1, 4, 1
    v_lshl_add_u32 v6, v7, 5, v6
    v_and_b32 v7, 1, v1
    v_lshl_add_u32 v6, v7, 4, v6
    v_bfe_u32 v7, v1, 1, 1
    v_lshl_add_u32 v6, v7, 3, v6
    v_add_u32 v6, 57344, v6
    v_lshrrev_b32 v5, 1, v5
    s_mul_i32 s60, s37, 3
    s_add_u32 s61, s60, 0
    v_xor_b32 v7, s61, v5
    v_lshl_add_u32 v20, v7, 6, v6
    v_add_u32 v24, 49152, v20
    s_add_u32 s61, s60, 1
    v_xor_b32 v7, s61, v5
    v_lshl_add_u32 v21, v7, 6, v6
    v_add_u32 v25, 49152, v21
    s_add_u32 s61, s60, 2
    v_xor_b32 v7, s61, v5
    v_lshl_add_u32 v22, v7, 6, v6
    v_add_u32 v26, 49152, v22
    s_mul_i32 s60, s89, 192
    s_mul_i32 s61, s37, 96
    s_add_u32 s60, s60, s61
    s_lshl_b32 s62, s88, 1
    s_add_u32 s62, s62, s36
    s_mul_i32 s62, s62, 114688
    s_lshl_b32 s61, s60, 6
    s_add_u32 s62, s62, s61
    s_add_u32 s63, s62, 4096
    s_add_u32 s61, s60, 0
    s_cmp_lt_u32 s61, 448
    s_cselect_b32 s78, 1049335798, 1065353216
    s_mov_b32 s79, s78
    s_add_u32 s61, s60, 32
    s_cmp_lt_u32 s61, 448
    s_cselect_b32 s80, 1049335798, 1065353216
    s_mov_b32 s81, s80
    s_add_u32 s61, s60, 64
    s_cmp_lt_u32 s61, 448
    s_cselect_b32 s82, 1049335798, 1065353216
    s_mov_b32 s83, s82
    v_lshlrev_b32 v5, 4, v1
    s_waitcnt vmcnt(6)
    s_waitcnt lgkmcnt(0)
    s_barrier
    ds_read_b128 v[96:99], v10 offset:0
    ds_read_b64_tr_b16 v[112:113], v20 offset:0
    ds_read_b64_tr_b16 v[114:115], v20 offset:1536
    ds_read_b64_tr_b16 v[116:117], v21 offset:0
    ds_read_b64_tr_b16 v[118:119], v21 offset:1536
    ds_read_b64_tr_b16 v[120:121], v22 offset:0
    ds_read_b64_tr_b16 v[122:123], v22 offset:1536
    ds_read_b128 v[100:103], v11 offset:0
    ds_read_b64_tr_b16 v[124:125], v20 offset:6144
    ds_read_b64_tr_b16 v[126:127], v20 offset:7680
    ds_read_b64_tr_b16 v[128:129], v21 offset:6144
    ds_read_b64_tr_b16 v[130:131], v21 offset:7680
    ds_read_b64_tr_b16 v[132:133], v22 offset:6144
    ds_read_b64_tr_b16 v[134:135], v22 offset:7680
    s_waitcnt lgkmcnt(11)
    v_mfma_f32_32x32x16_bf16 v[32:47], v[112:115], v[96:99], 0
    ds_read_b128 v[104:107], v12 offset:0
    ds_read_b64_tr_b16 v[136:137], v20 offset:12288
    ds_read_b64_tr_b16 v[138:139], v20 offset:13824
    s_waitcnt lgkmcnt(12)
    v_mfma_f32_32x32x16_bf16 v[48:63], v[116:119], v[96:99], 0
    ds_read_b64_tr_b16 v[140:141], v21 offset:12288
    ds_read_b64_tr_b16 v[142:143], v21 offset:13824
    s_waitcnt lgkmcnt(12)
    v_mfma_f32_32x32x16_bf16 v[64:79], v[120:123], v[96:99], 0
    ds_read_b64_tr_b16 v[144:145], v22 offset:12288
    ds_read_b64_tr_b16 v[146:147], v22 offset:13824
    s_waitcnt lgkmcnt(11)
    v_mfma_f32_32x32x16_bf16 v[32:47], v[124:127], v[100:103], v[32:47]
    ds_read_b128 v[96:99], v13 offset:0
    ds_read_b64_tr_b16 v[112:113], v20 offset:18432
    ds_read_b64_tr_b16 v[114:115], v20 offset:19968
    s_waitcnt lgkmcnt(12)
    v_mfma_f32_32x32x16_bf16 v[48:63], v[128:131], v[100:103], v[48:63]
    ds_read_b64_tr_b16 v[116:117], v21 offset:18432
    ds_read_b64_tr_b16 v[118:119], v21 offset:19968
    s_waitcnt lgkmcnt(12)
    v_mfma_f32_32x32x16_bf16 v[64:79], v[132:135], v[100:103], v[64:79]
    ds_read_b64_tr_b16 v[120:121], v22 offset:18432
    ds_read_b64_tr_b16 v[122:123], v22 offset:19968
    s_waitcnt lgkmcnt(11)
    v_mfma_f32_32x32x16_bf16 v[32:47], v[136:139], v[104:107], v[32:47]
    s_waitcnt vmcnt(0)
    s_barrier
    ds_read_b128 v[100:103], v10 offset:8192
    ds_read_b64_tr_b16 v[124:125], v20 offset:24576
    ds_read_b64_tr_b16 v[126:127], v20 offset:26112
    s_waitcnt lgkmcnt(12)
    v_mfma_f32_32x32x16_bf16 v[48:63], v[140:143], v[104:107], v[48:63]
    ds_read_b64_tr_b16 v[128:129], v21 offset:24576
    ds_read_b64_tr_b16 v[130:131], v21 offset:26112
    s_waitcnt lgkmcnt(12)
    v_mfma_f32_32x32x16_bf16 v[64:79], v[144:147], v[104:107], v[64:79]
    ds_read_b64_tr_b16 v[132:133], v22 offset:24576
    ds_read_b64_tr_b16 v[134:135], v22 offset:26112
    s_waitcnt lgkmcnt(11)
    v_mfma_f32_32x32x16_bf16 v[32:47], v[112:115], v[96:99], v[32:47]
    ds_read_b128 v[104:107], v11 offset:8192
    ds_read_b64_tr_b16 v[136:137], v20 offset:30720
    ds_read_b64_tr_b16 v[138:139], v20 offset:32256
    s_waitcnt lgkmcnt(12)
    v_mfma_f32_32x32x16_bf16 v[48:63], v[116:119], v[96:99], v[48:63]
    ds_read_b64_tr_b16 v[140:141], v21 offset:30720
    ds_read_b64_tr_b16 v[142:143], v21 offset:32256
    s_waitcnt lgkmcnt(12)
    v_mfma_f32_32x32x16_bf16 v[64:79], v[120:123], v[96:99], v[64:79]
    ds_read_b64_tr_b16 v[144:145], v22 offset:30720
    ds_read_b64_tr_b16 v[146:147], v22 offset:32256
    s_waitcnt lgkmcnt(11)
    v_mfma_f32_32x32x16_bf16 v[32:47], v[124:127], v[100:103], v[32:47]
    ds_read_b128 v[96:99], v12 offset:8192
    ds_read_b64_tr_b16 v[112:113], v20 offset:36864
    ds_read_b64_tr_b16 v[114:115], v20 offset:38400
    s_waitcnt lgkmcnt(12)
    v_mfma_f32_32x32x16_bf16 v[48:63], v[128:131], v[100:103], v[48:63]
    ds_read_b64_tr_b16 v[116:117], v21 offset:36864
    ds_read_b64_tr_b16 v[118:119], v21 offset:38400
    s_waitcnt lgkmcnt(12)
    v_mfma_f32_32x32x16_bf16 v[64:79], v[132:135], v[100:103], v[64:79]
    ds_read_b64_tr_b16 v[120:121], v22 offset:36864
    ds_read_b64_tr_b16 v[122:123], v22 offset:38400
    s_waitcnt lgkmcnt(11)
    v_mfma_f32_32x32x16_bf16 v[32:47], v[136:139], v[104:107], v[32:47]
    ds_read_b128 v[100:103], v13 offset:8192
    ds_read_b64_tr_b16 v[124:125], v20 offset:43008
    ds_read_b64_tr_b16 v[126:127], v20 offset:44544
    s_waitcnt lgkmcnt(12)
    v_mfma_f32_32x32x16_bf16 v[48:63], v[140:143], v[104:107], v[48:63]
    ds_read_b64_tr_b16 v[128:129], v21 offset:43008
    ds_read_b64_tr_b16 v[130:131], v21 offset:44544
    s_waitcnt lgkmcnt(12)
    v_mfma_f32_32x32x16_bf16 v[64:79], v[144:147], v[104:107], v[64:79]
    ds_read_b64_tr_b16 v[132:133], v22 offset:43008
    ds_read_b64_tr_b16 v[134:135], v22 offset:44544
    s_waitcnt lgkmcnt(11)
    v_mfma_f32_32x32x16_bf16 v[32:47], v[112:115], v[96:99], v[32:47]
    s_barrier
    ds_read_b128 v[104:107], v10 offset:16384
    ds_read_b64_tr_b16 v[136:137], v24 offset:0
    ds_read_b64_tr_b16 v[138:139], v24 offset:1536
    s_waitcnt lgkmcnt(12)
    v_mfma_f32_32x32x16_bf16 v[48:63], v[116:119], v[96:99], v[48:63]
    ds_read_b64_tr_b16 v[140:141], v25 offset:0
    ds_read_b64_tr_b16 v[142:143], v25 offset:1536
    s_waitcnt lgkmcnt(12)
    v_mfma_f32_32x32x16_bf16 v[64:79], v[120:123], v[96:99], v[64:79]
    ds_read_b64_tr_b16 v[144:145], v26 offset:0
    ds_read_b64_tr_b16 v[146:147], v26 offset:1536
    s_waitcnt lgkmcnt(11)
    v_mfma_f32_32x32x16_bf16 v[32:47], v[124:127], v[100:103], v[32:47]
    ds_read_b128 v[96:99], v11 offset:16384
    ds_read_b64_tr_b16 v[112:113], v24 offset:6144
    ds_read_b64_tr_b16 v[114:115], v24 offset:7680
    s_waitcnt lgkmcnt(12)
    v_mfma_f32_32x32x16_bf16 v[48:63], v[128:131], v[100:103], v[48:63]
    ds_read_b64_tr_b16 v[116:117], v25 offset:6144
    ds_read_b64_tr_b16 v[118:119], v25 offset:7680
    s_waitcnt lgkmcnt(12)
    v_mfma_f32_32x32x16_bf16 v[64:79], v[132:135], v[100:103], v[64:79]
    ds_read_b64_tr_b16 v[120:121], v26 offset:6144
    ds_read_b64_tr_b16 v[122:123], v26 offset:7680
    s_waitcnt lgkmcnt(11)
    v_mfma_f32_32x32x16_bf16 v[32:47], v[136:139], v[104:107], v[32:47]
    ds_read_b128 v[100:103], v12 offset:16384
    ds_read_b64_tr_b16 v[124:125], v24 offset:12288
    ds_read_b64_tr_b16 v[126:127], v24 offset:13824
    s_waitcnt lgkmcnt(12)
    v_mfma_f32_32x32x16_bf16 v[48:63], v[140:143], v[104:107], v[48:63]
    ds_read_b64_tr_b16 v[128:129], v25 offset:12288
    ds_read_b64_tr_b16 v[130:131], v25 offset:13824
    s_waitcnt lgkmcnt(12)
    v_mfma_f32_32x32x16_bf16 v[64:79], v[144:147], v[104:107], v[64:79]
    ds_read_b64_tr_b16 v[132:133], v26 offset:12288
    ds_read_b64_tr_b16 v[134:135], v26 offset:13824
    s_waitcnt lgkmcnt(11)
    v_mfma_f32_32x32x16_bf16 v[32:47], v[112:115], v[96:99], v[32:47]
    ds_read_b128 v[104:107], v13 offset:16384
    ds_read_b64_tr_b16 v[136:137], v24 offset:18432
    ds_read_b64_tr_b16 v[138:139], v24 offset:19968
    s_waitcnt lgkmcnt(12)
    v_mfma_f32_32x32x16_bf16 v[48:63], v[116:119], v[96:99], v[48:63]
    ds_read_b64_tr_b16 v[140:141], v25 offset:18432
    ds_read_b64_tr_b16 v[142:143], v25 offset:19968
    s_waitcnt lgkmcnt(12)
    v_mfma_f32_32x32x16_bf16 v[64:79], v[120:123], v[96:99], v[64:79]
    ds_read_b64_tr_b16 v[144:145], v26 offset:18432
    ds_read_b64_tr_b16 v[146:147], v26 offset:19968
    s_waitcnt lgkmcnt(11)
    v_mfma_f32_32x32x16_bf16 v[32:47], v[124:127], v[100:103], v[32:47]
    s_barrier
    ds_read_b128 v[96:99], v10 offset:24576
    ds_read_b64_tr_b16 v[112:113], v24 offset:24576
    ds_read_b64_tr_b16 v[114:115], v24 offset:26112
    s_waitcnt lgkmcnt(12)
    v_mfma_f32_32x32x16_bf16 v[48:63], v[128:131], v[100:103], v[48:63]
    ds_read_b64_tr_b16 v[116:117], v25 offset:24576
    ds_read_b64_tr_b16 v[118:119], v25 offset:26112
    s_waitcnt lgkmcnt(12)
    v_mfma_f32_32x32x16_bf16 v[64:79], v[132:135], v[100:103], v[64:79]
    ds_read_b64_tr_b16 v[120:121], v26 offset:24576
    ds_read_b64_tr_b16 v[122:123], v26 offset:26112
    s_waitcnt lgkmcnt(11)
    v_mfma_f32_32x32x16_bf16 v[32:47], v[136:139], v[104:107], v[32:47]
    ds_read_b128 v[100:103], v11 offset:24576
    ds_read_b64_tr_b16 v[124:125], v24 offset:30720
    ds_read_b64_tr_b16 v[126:127], v24 offset:32256
    s_waitcnt lgkmcnt(12)
    v_mfma_f32_32x32x16_bf16 v[48:63], v[140:143], v[104:107], v[48:63]
    ds_read_b64_tr_b16 v[128:129], v25 offset:30720
    ds_read_b64_tr_b16 v[130:131], v25 offset:32256
    s_waitcnt lgkmcnt(12)
    v_mfma_f32_32x32x16_bf16 v[64:79], v[144:147], v[104:107], v[64:79]
    ds_read_b64_tr_b16 v[132:133], v26 offset:30720
    ds_read_b64_tr_b16 v[134:135], v26 offset:32256
    s_waitcnt lgkmcnt(11)
    v_mfma_f32_32x32x16_bf16 v[32:47], v[112:115], v[96:99], v[32:47]
    ds_read_b128 v[104:107], v12 offset:24576
    ds_read_b64_tr_b16 v[136:137], v24 offset:36864
    ds_read_b64_tr_b16 v[138:139], v24 offset:38400
    s_waitcnt lgkmcnt(12)
    v_mfma_f32_32x32x16_bf16 v[48:63], v[116:119], v[96:99], v[48:63]
    ds_read_b64_tr_b16 v[140:141], v25 offset:36864
    ds_read_b64_tr_b16 v[142:143], v25 offset:38400
    s_waitcnt lgkmcnt(12)
    v_mfma_f32_32x32x16_bf16 v[64:79], v[120:123], v[96:99], v[64:79]
    ds_read_b64_tr_b16 v[144:145], v26 offset:36864
    ds_read_b64_tr_b16 v[146:147], v26 offset:38400
    s_waitcnt lgkmcnt(11)
    v_mfma_f32_32x32x16_bf16 v[32:47], v[124:127], v[100:103], v[32:47]
    ds_read_b128 v[96:99], v13 offset:24576
    ds_read_b64_tr_b16 v[112:113], v24 offset:43008
    ds_read_b64_tr_b16 v[114:115], v24 offset:44544
    s_waitcnt lgkmcnt(12)
    v_mfma_f32_32x32x16_bf16 v[48:63], v[128:131], v[100:103], v[48:63]
    ds_read_b64_tr_b16 v[116:117], v25 offset:43008
    ds_read_b64_tr_b16 v[118:119], v25 offset:44544
    s_waitcnt lgkmcnt(12)
    v_mfma_f32_32x32x16_bf16 v[64:79], v[132:135], v[100:103], v[64:79]
    ds_read_b64_tr_b16 v[120:121], v26 offset:43008
    ds_read_b64_tr_b16 v[122:123], v26 offset:44544
    s_waitcnt lgkmcnt(11)
    v_mfma_f32_32x32x16_bf16 v[32:47], v[136:139], v[104:107], v[32:47]
    s_barrier
    ds_read_b128 v[100:103], v10 offset:32768
    ds_read_b64_tr_b16 v[124:125], v20 offset:0
    ds_read_b64_tr_b16 v[126:127], v20 offset:1536
    s_waitcnt lgkmcnt(12)
    v_mfma_f32_32x32x16_bf16 v[48:63], v[140:143], v[104:107], v[48:63]
    ds_read_b64_tr_b16 v[128:129], v21 offset:0
    ds_read_b64_tr_b16 v[130:131], v21 offset:1536
    s_waitcnt lgkmcnt(12)
    v_mfma_f32_32x32x16_bf16 v[64:79], v[144:147], v[104:107], v[64:79]
    ds_read_b64_tr_b16 v[132:133], v22 offset:0
    ds_read_b64_tr_b16 v[134:135], v22 offset:1536
    s_waitcnt lgkmcnt(11)
    v_mfma_f32_32x32x16_bf16 v[32:47], v[112:115], v[96:99], v[32:47]
    ds_read_b128 v[104:107], v11 offset:32768
    ds_read_b64_tr_b16 v[136:137], v20 offset:6144
    ds_read_b64_tr_b16 v[138:139], v20 offset:7680
    s_waitcnt lgkmcnt(12)
    v_mfma_f32_32x32x16_bf16 v[48:63], v[116:119], v[96:99], v[48:63]
    ds_read_b64_tr_b16 v[140:141], v21 offset:6144
    ds_read_b64_tr_b16 v[142:143], v21 offset:7680
    s_waitcnt lgkmcnt(12)
    v_mfma_f32_32x32x16_bf16 v[64:79], v[120:123], v[96:99], v[64:79]
    ds_read_b64_tr_b16 v[144:145], v22 offset:6144
    ds_read_b64_tr_b16 v[146:147], v22 offset:7680
    s_waitcnt lgkmcnt(11)
    v_mfma_f32_32x32x16_bf16 v[32:47], v[124:127], v[100:103], v[32:47]
    ds_read_b128 v[96:99], v12 offset:32768
    ds_read_b64_tr_b16 v[112:113], v20 offset:12288
    ds_read_b64_tr_b16 v[114:115], v20 offset:13824
    s_waitcnt lgkmcnt(12)
    v_mfma_f32_32x32x16_bf16 v[48:63], v[128:131], v[100:103], v[48:63]
    ds_read_b64_tr_b16 v[116:117], v21 offset:12288
    ds_read_b64_tr_b16 v[118:119], v21 offset:13824
    s_waitcnt lgkmcnt(12)
    v_mfma_f32_32x32x16_bf16 v[64:79], v[132:135], v[100:103], v[64:79]
    ds_read_b64_tr_b16 v[120:121], v22 offset:12288
    ds_read_b64_tr_b16 v[122:123], v22 offset:13824
    s_waitcnt lgkmcnt(11)
    v_mfma_f32_32x32x16_bf16 v[32:47], v[136:139], v[104:107], v[32:47]
    ds_read_b128 v[100:103], v13 offset:32768
    ds_read_b64_tr_b16 v[124:125], v20 offset:18432
    ds_read_b64_tr_b16 v[126:127], v20 offset:19968
    s_waitcnt lgkmcnt(12)
    v_mfma_f32_32x32x16_bf16 v[48:63], v[140:143], v[104:107], v[48:63]
    ds_read_b64_tr_b16 v[128:129], v21 offset:18432
    ds_read_b64_tr_b16 v[130:131], v21 offset:19968
    s_waitcnt lgkmcnt(12)
    v_mfma_f32_32x32x16_bf16 v[64:79], v[144:147], v[104:107], v[64:79]
    ds_read_b64_tr_b16 v[132:133], v22 offset:18432
    ds_read_b64_tr_b16 v[134:135], v22 offset:19968
    s_waitcnt lgkmcnt(11)
    v_mfma_f32_32x32x16_bf16 v[32:47], v[112:115], v[96:99], v[32:47]
    s_barrier
    ds_read_b128 v[104:107], v10 offset:40960
    ds_read_b64_tr_b16 v[136:137], v20 offset:24576
    ds_read_b64_tr_b16 v[138:139], v20 offset:26112
    s_waitcnt lgkmcnt(12)
    v_mfma_f32_32x32x16_bf16 v[48:63], v[116:119], v[96:99], v[48:63]
    ds_read_b64_tr_b16 v[140:141], v21 offset:24576
    ds_read_b64_tr_b16 v[142:143], v21 offset:26112
    s_waitcnt lgkmcnt(12)
    v_mfma_f32_32x32x16_bf16 v[64:79], v[120:123], v[96:99], v[64:79]
    ds_read_b64_tr_b16 v[144:145], v22 offset:24576
    ds_read_b64_tr_b16 v[146:147], v22 offset:26112
    s_waitcnt lgkmcnt(11)
    v_mfma_f32_32x32x16_bf16 v[32:47], v[124:127], v[100:103], v[32:47]
    ds_read_b128 v[96:99], v11 offset:40960
    ds_read_b64_tr_b16 v[112:113], v20 offset:30720
    ds_read_b64_tr_b16 v[114:115], v20 offset:32256
    s_waitcnt lgkmcnt(12)
    v_mfma_f32_32x32x16_bf16 v[48:63], v[128:131], v[100:103], v[48:63]
    ds_read_b64_tr_b16 v[116:117], v21 offset:30720
    ds_read_b64_tr_b16 v[118:119], v21 offset:32256
    s_waitcnt lgkmcnt(12)
    v_mfma_f32_32x32x16_bf16 v[64:79], v[132:135], v[100:103], v[64:79]
    ds_read_b64_tr_b16 v[120:121], v22 offset:30720
    ds_read_b64_tr_b16 v[122:123], v22 offset:32256
    s_waitcnt lgkmcnt(11)
    v_mfma_f32_32x32x16_bf16 v[32:47], v[136:139], v[104:107], v[32:47]
    ds_read_b128 v[100:103], v12 offset:40960
    ds_read_b64_tr_b16 v[124:125], v20 offset:36864
    ds_read_b64_tr_b16 v[126:127], v20 offset:38400
    s_waitcnt lgkmcnt(12)
    v_mfma_f32_32x32x16_bf16 v[48:63], v[140:143], v[104:107], v[48:63]
    ds_read_b64_tr_b16 v[128:129], v21 offset:36864
    ds_read_b64_tr_b16 v[130:131], v21 offset:38400
    s_waitcnt lgkmcnt(12)
    v_mfma_f32_32x32x16_bf16 v[64:79], v[144:147], v[104:107], v[64:79]
    ds_read_b64_tr_b16 v[132:133], v22 offset:36864
    ds_read_b64_tr_b16 v[134:135], v22 offset:38400
    s_waitcnt lgkmcnt(11)
    v_mfma_f32_32x32x16_bf16 v[32:47], v[112:115], v[96:99], v[32:47]
    ds_read_b128 v[104:107], v13 offset:40960
    ds_read_b64_tr_b16 v[136:137], v20 offset:43008
    ds_read_b64_tr_b16 v[138:139], v20 offset:44544
    s_waitcnt lgkmcnt(12)
    v_mfma_f32_32x32x16_bf16 v[48:63], v[116:119], v[96:99], v[48:63]
    ds_read_b64_tr_b16 v[140:141], v21 offset:43008
    ds_read_b64_tr_b16 v[142:143], v21 offset:44544
    s_waitcnt lgkmcnt(12)
    v_mfma_f32_32x32x16_bf16 v[64:79], v[120:123], v[96:99], v[64:79]
    ds_read_b64_tr_b16 v[144:145], v22 offset:43008
    ds_read_b64_tr_b16 v[146:147], v22 offset:44544
    s_waitcnt lgkmcnt(11)
    v_mfma_f32_32x32x16_bf16 v[32:47], v[124:127], v[100:103], v[32:47]
    s_barrier
    ds_read_b128 v[96:99], v10 offset:49152
    ds_read_b64_tr_b16 v[112:113], v24 offset:0
    ds_read_b64_tr_b16 v[114:115], v24 offset:1536
    s_waitcnt lgkmcnt(12)
    v_mfma_f32_32x32x16_bf16 v[48:63], v[128:131], v[100:103], v[48:63]
    ds_read_b64_tr_b16 v[116:117], v25 offset:0
    ds_read_b64_tr_b16 v[118:119], v25 offset:1536
    s_waitcnt lgkmcnt(12)
    v_mfma_f32_32x32x16_bf16 v[64:79], v[132:135], v[100:103], v[64:79]
    ds_read_b64_tr_b16 v[120:121], v26 offset:0
    ds_read_b64_tr_b16 v[122:123], v26 offset:1536
    s_waitcnt lgkmcnt(11)
    v_mfma_f32_32x32x16_bf16 v[32:47], v[136:139], v[104:107], v[32:47]
    ds_read_b128 v[100:103], v11 offset:49152
    ds_read_b64_tr_b16 v[124:125], v24 offset:6144
    ds_read_b64_tr_b16 v[126:127], v24 offset:7680
    s_waitcnt lgkmcnt(12)
    v_mfma_f32_32x32x16_bf16 v[48:63], v[140:143], v[104:107], v[48:63]
    ds_read_b64_tr_b16 v[128:129], v25 offset:6144
    ds_read_b64_tr_b16 v[130:131], v25 offset:7680
    s_waitcnt lgkmcnt(12)
    v_mfma_f32_32x32x16_bf16 v[64:79], v[144:147], v[104:107], v[64:79]
    ds_read_b64_tr_b16 v[132:133], v26 offset:6144
    ds_read_b64_tr_b16 v[134:135], v26 offset:7680
    s_waitcnt lgkmcnt(11)
    v_mfma_f32_32x32x16_bf16 v[32:47], v[112:115], v[96:99], v[32:47]
    ds_read_b128 v[104:107], v12 offset:49152
    ds_read_b64_tr_b16 v[136:137], v24 offset:12288
    ds_read_b64_tr_b16 v[138:139], v24 offset:13824
    s_waitcnt lgkmcnt(12)
    v_mfma_f32_32x32x16_bf16 v[48:63], v[116:119], v[96:99], v[48:63]
    ds_read_b64_tr_b16 v[140:141], v25 offset:12288
    ds_read_b64_tr_b16 v[142:143], v25 offset:13824
    s_waitcnt lgkmcnt(12)
    v_mfma_f32_32x32x16_bf16 v[64:79], v[120:123], v[96:99], v[64:79]
    ds_read_b64_tr_b16 v[144:145], v26 offset:12288
    ds_read_b64_tr_b16 v[146:147], v26 offset:13824
    s_waitcnt lgkmcnt(11)
    v_mfma_f32_32x32x16_bf16 v[32:47], v[124:127], v[100:103], v[32:47]
    ds_read_b128 v[96:99], v13 offset:49152
    ds_read_b64_tr_b16 v[112:113], v24 offset:18432
    ds_read_b64_tr_b16 v[114:115], v24 offset:19968
    s_waitcnt lgkmcnt(12)
    v_mfma_f32_32x32x16_bf16 v[48:63], v[128:131], v[100:103], v[48:63]
    ds_read_b64_tr_b16 v[116:117], v25 offset:18432
    ds_read_b64_tr_b16 v[118:119], v25 offset:19968
    s_waitcnt lgkmcnt(12)
    v_mfma_f32_32x32x16_bf16 v[64:79], v[132:135], v[100:103], v[64:79]
    ds_read_b64_tr_b16 v[120:121], v26 offset:18432
    ds_read_b64_tr_b16 v[122:123], v26 offset:19968
    s_waitcnt lgkmcnt(11)
    v_mfma_f32_32x32x16_bf16 v[32:47], v[136:139], v[104:107], v[32:47]
    s_waitcnt lgkmcnt(9)
    v_mfma_f32_32x32x16_bf16 v[48:63], v[140:143], v[104:107], v[48:63]
    s_waitcnt lgkmcnt(7)
    v_mfma_f32_32x32x16_bf16 v[64:79], v[144:147], v[104:107], v[64:79]
    s_waitcnt lgkmcnt(4)
    v_mfma_f32_32x32x16_bf16 v[32:47], v[112:115], v[96:99], v[32:47]
    s_waitcnt lgkmcnt(2)
    v_mfma_f32_32x32x16_bf16 v[48:63], v[116:119], v[96:99], v[48:63]
    s_waitcnt lgkmcnt(0)
    v_mfma_f32_32x32x16_bf16 v[64:79], v[120:123], v[96:99], v[64:79]
    s_nop 7
    s_nop 1
    v_pk_mul_f32 v[32:33], v[32:33], s[78:79]
    v_pk_mul_f32 v[34:35], v[34:35], s[78:79]
    v_pk_mul_f32 v[36:37], v[36:37], s[78:79]
    v_pk_mul_f32 v[38:39], v[38:39], s[78:79]
    v_pk_mul_f32 v[40:41], v[40:41], s[78:79]
    v_pk_mul_f32 v[42:43], v[42:43], s[78:79]
    v_pk_mul_f32 v[44:45], v[44:45], s[78:79]
    v_pk_mul_f32 v[46:47], v[46:47], s[78:79]
    v_cvt_pk_bf16_f32 v160, v32, v33
    v_cvt_pk_bf16_f32 v161, v34, v35
    v_cvt_pk_bf16_f32 v162, v36, v37
    v_cvt_pk_bf16_f32 v163, v38, v39
    v_cvt_pk_bf16_f32 v164, v40, v41
    v_cvt_pk_bf16_f32 v165, v42, v43
    v_cvt_pk_bf16_f32 v166, v44, v45
    v_cvt_pk_bf16_f32 v167, v46, v47
    buffer_store_dwordx4 v[160:163], v5, s[56:59], s62 offen offset:0
    buffer_store_dwordx4 v[164:167], v5, s[56:59], s62 offen offset:1024
    v_pk_mul_f32 v[48:49], v[48:49], s[80:81]
    v_pk_mul_f32 v[50:51], v[50:51], s[80:81]
    v_pk_mul_f32 v[52:53], v[52:53], s[80:81]
    v_pk_mul_f32 v[54:55], v[54:55], s[80:81]
    v_pk_mul_f32 v[56:57], v[56:57], s[80:81]
    v_pk_mul_f32 v[58:59], v[58:59], s[80:81]
    v_pk_mul_f32 v[60:61], v[60:61], s[80:81]
    v_pk_mul_f32 v[62:63], v[62:63], s[80:81]
    v_cvt_pk_bf16_f32 v168, v48, v49
    v_cvt_pk_bf16_f32 v169, v50, v51
    v_cvt_pk_bf16_f32 v170, v52, v53
    v_cvt_pk_bf16_f32 v171, v54, v55
    v_cvt_pk_bf16_f32 v172, v56, v57
    v_cvt_pk_bf16_f32 v173, v58, v59
    v_cvt_pk_bf16_f32 v174, v60, v61
    v_cvt_pk_bf16_f32 v175, v62, v63
    buffer_store_dwordx4 v[168:171], v5, s[56:59], s62 offen offset:2048
    buffer_store_dwordx4 v[172:175], v5, s[56:59], s62 offen offset:3072
    v_pk_mul_f32 v[64:65], v[64:65], s[82:83]
    v_pk_mul_f32 v[66:67], v[66:67], s[82:83]
    v_pk_mul_f32 v[68:69], v[68:69], s[82:83]
    v_pk_mul_f32 v[70:71], v[70:71], s[82:83]
    v_pk_mul_f32 v[72:73], v[72:73], s[82:83]
    v_pk_mul_f32 v[74:75], v[74:75], s[82:83]
    v_pk_mul_f32 v[76:77], v[76:77], s[82:83]
    v_pk_mul_f32 v[78:79], v[78:79], s[82:83]
    v_cvt_pk_bf16_f32 v176, v64, v65
    v_cvt_pk_bf16_f32 v177, v66, v67
    v_cvt_pk_bf16_f32 v178, v68, v69
    v_cvt_pk_bf16_f32 v179, v70, v71
    v_cvt_pk_bf16_f32 v180, v72, v73
    v_cvt_pk_bf16_f32 v181, v74, v75
    v_cvt_pk_bf16_f32 v182, v76, v77
    v_cvt_pk_bf16_f32 v183, v78, v79
    buffer_store_dwordx4 v[176:179], v5, s[56:59], s63 offen offset:0
    buffer_store_dwordx4 v[180:183], v5, s[56:59], s63 offen offset:1024
    s_endpgm
L_ka_spare:
    s_sub_u32 s36, s26, 28
    s_lshl_b32 s36, s36, 3
    s_add_u32 s36, s36, s25
    s_mul_hi_u32 s37, s36, 306783379
    s_mul_i32 s39, s37, 14
    s_sub_u32 s38, s36, s39
    v_lshrrev_b32 v3, 4, v1
    s_lshl_b32 s39, s24, 2
    v_add_u32 v3, s39, v3
    v_mul_u32_u24 v4, 3584, v3
    v_and_b32 v5, 15, v1
    v_lshl_add_u32 v4, v5, 4, v4
    s_waitcnt lgkmcnt(0)
    s_cmp_lt_u32 s36, 28
    s_cbranch_scc1 L_ka_cs
    s_cmp_lg_u32 s36, 31
    s_cbranch_scc1 L_ka_end
    s_add_u32 s28, s22, 19922944
    s_addc_u32 s29, s23, 0
    s_and_b32 s29, s29, 0xffff
    s_mov_b32 s30, 8192
    s_mov_b32 s31, 0x00020000
    v_lshlrev_b32 v3, 4, v0
    v_mov_b32 v4, 0
    v_mov_b32 v5, 0
    v_mov_b32 v6, 0
    v_mov_b32 v7, 0
    buffer_store_dwordx4 v[4:7], v3, s[28:31], 0 offen
    s_endpgm
L_ka_cs:
    s_cmp_eq_u32 s37, 0
    s_cselect_b32 s40, s12, s14
    s_cselect_b32 s41, s13, s15
    s_mov_b32 s48, s40
    s_mov_b32 s49, s41
    s_and_b32 s49, s49, 0xffff
    s_mov_b32 s50, 1605632
    s_mov_b32 s51, 0x00020000
    s_add_u32 s52, s22, 18874368
    s_addc_u32 s53, s23, 0
    s_and_b32 s53, s53, 0xffff
    s_mov_b32 s54, 14336
    s_mov_b32 s55, 0x00020000
    s_lshl_b32 s42, s38, 8
    s_add_u32 s43, s42, 0
    buffer_load_dwordx4 v[32:35], v4, s[48:51], s43 offen
    s_add_u32 s43, s42, 114688
    buffer_load_dwordx4 v[36:39], v4, s[48:51], s43 offen
    s_add_u32 s43, s42, 229376
    buffer_load_dwordx4 v[40:43], v4, s[48:51], s43 offen
    s_add_u32 s43, s42, 344064
    buffer_load_dwordx4 v[44:47], v4, s[48:51], s43 offen
    v_mov_b32 v16, 0
    v_mov_b32 v17, 0
    v_mov_b32 v18, 0
    v_mov_b32 v19, 0
    v_mov_b32 v20, 0
    v_mov_b32 v21, 0
    v_mov_b32 v22, 0
    v_mov_b32 v23, 0
    s_waitcnt vmcnt(3)
    s_add_u32 s43, s42, 458752
    buffer_load_dwordx4 v[48:51], v4, s[48:51], s43 offen
    v_lshlrev_b32 v24, 16, v32
    v_and_b32 v25, 0xffff0000, v32
    v_lshlrev_b32 v26, 16, v33
    v_and_b32 v27, 0xffff0000, v33
    v_lshlrev_b32 v28, 16, v34
    v_and_b32 v29, 0xffff0000, v34
    v_lshlrev_b32 v30, 16, v35
    v_and_b32 v31, 0xffff0000, v35
    v_pk_add_f32 v[16:17], v[16:17], v[24:25]
    v_pk_add_f32 v[18:19], v[18:19], v[26:27]
    v_pk_add_f32 v[20:21], v[20:21], v[28:29]
    v_pk_add_f32 v[22:23], v[22:23], v[30:31]
    s_waitcnt vmcnt(3)
    s_add_u32 s43, s42, 573440
    buffer_load_dwordx4 v[52:55], v4, s[48:51], s43 offen
    v_lshlrev_b32 v24, 16, v36
    v_and_b32 v25, 0xffff0000, v36
    v_lshlrev_b32 v26, 16, v37
    v_and_b32 v27, 0xffff0000, v37
    v_lshlrev_b32 v28, 16, v38
    v_and_b32 v29, 0xffff0000, v38
    v_lshlrev_b32 v30, 16, v39
    v_and_b32 v31, 0xffff0000, v39
    v_pk_add_f32 v[16:17], v[16:17], v[24:25]
    v_pk_add_f32 v[18:19], v[18:19], v[26:27]
    v_pk_add_f32 v[20:21], v[20:21], v[28:29]
    v_pk_add_f32 v[22:23], v[22:23], v[30:31]
    s_waitcnt vmcnt(3)
    s_add_u32 s43, s42, 688128
    buffer_load_dwordx4 v[56:59], v4, s[48:51], s43 offen
    v_lshlrev_b32 v24, 16, v40
    v_and_b32 v25, 0xffff0000, v40
    v_lshlrev_b32 v26, 16, v41
    v_and_b32 v27, 0xffff0000, v41
    v_lshlrev_b32 v28, 16, v42
    v_and_b32 v29, 0xffff0000, v42
    v_lshlrev_b32 v30, 16, v43
    v_and_b32 v31, 0xffff0000, v43
    v_pk_add_f32 v[16:17], v[16:17], v[24:25]
    v_pk_add_f32 v[18:19], v[18:19], v[26:27]
    v_pk_add_f32 v[20:21], v[20:21], v[28:29]
    v_pk_add_f32 v[22:23], v[22:23], v[30:31]
    s_waitcnt vmcnt(3)
    s_add_u32 s43, s42, 802816
    buffer_load_dwordx4 v[60:63], v4, s[48:51], s43 offen
    v_lshlrev_b32 v24, 16, v44
    v_and_b32 v25, 0xffff0000, v44
    v_lshlrev_b32 v26, 16, v45
    v_and_b32 v27, 0xffff0000, v45
    v_lshlrev_b32 v28, 16, v46
    v_and_b32 v29, 0xffff0000, v46
    v_lshlrev_b32 v30, 16, v47
    v_and_b32 v31, 0xffff0000, v47
    v_pk_add_f32 v[16:17], v[16:17], v[24:25]
    v_pk_add_f32 v[18:19], v[18:19], v[26:27]
    v_pk_add_f32 v[20:21], v[20:21], v[28:29]
    v_pk_add_f32 v[22:23], v[22:23], v[30:31]
    s_waitcnt vmcnt(3)
    s_add_u32 s43, s42, 917504
    buffer_load_dwordx4 v[64:67], v4, s[48:51], s43 offen
    v_lshlrev_b32 v24, 16, v48
    v_and_b32 v25, 0xffff0000, v48
    v_lshlrev_b32 v26, 16, v49
    v_and_b32 v27, 0xffff0000, v49
    v_lshlrev_b32 v28, 16, v50
    v_and_b32 v29, 0xffff0000, v50
    v_lshlrev_b32 v30, 16, v51
    v_and_b32 v31, 0xffff0000, v51
    v_pk_add_f32 v[16:17], v[16:17], v[24:25]
    v_pk_add_f32 v[18:19], v[18:19], v[26:27]
    v_pk_add_f32 v[20:21], v[20:21], v[28:29]
    v_pk_add_f32 v[22:23], v[22:23], v[30:31]
    s_waitcnt vmcnt(3)
    s_add_u32 s43, s42, 1032192
    buffer_load_dwordx4 v[68:71], v4, s[48:51], s43 offen
    v_lshlrev_b32 v24, 16, v52
    v_and_b32 v25, 0xffff0000, v52
    v_lshlrev_b32 v26, 16, v53
    v_and_b32 v27, 0xffff0000, v53
    v_lshlrev_b32 v28, 16, v54
    v_and_b32 v29, 0xffff0000, v54
    v_lshlrev_b32 v30, 16, v55
    v_and_b32 v31, 0xffff0000, v55
    v_pk_add_f32 v[16:17], v[16:17], v[24:25]
    v_pk_add_f32 v[18:19], v[18:19], v[26:27]
    v_pk_add_f32 v[20:21], v[20:21], v[28:29]
    v_pk_add_f32 v[22:23], v[22:23], v[30:31]
    s_waitcnt vmcnt(3)
    s_add_u32 s43, s42, 1146880
    buffer_load_dwordx4 v[72:75], v4, s[48:51], s43 offen
    v_lshlrev_b32 v24, 16, v56
    v_and_b32 v25, 0xffff0000, v56
    v_lshlrev_b32 v26, 16, v57
    v_and_b32 v27, 0xffff0000, v57
    v_lshlrev_b32 v28, 16, v58
    v_and_b32 v29, 0xffff0000, v58
    v_lshlrev_b32 v30, 16, v59
    v_and_b32 v31, 0xffff0000, v59
    v_pk_add_f32 v[16:17], v[16:17], v[24:25]
    v_pk_add_f32 v[18:19], v[18:19], v[26:27]
    v_pk_add_f32 v[20:21], v[20:21], v[28:29]
    v_pk_add_f32 v[22:23], v[22:23], v[30:31]
    s_waitcnt vmcnt(3)
    s_add_u32 s43, s42, 1261568
    buffer_load_dwordx4 v[76:79], v4, s[48:51], s43 offen
    v_lshlrev_b32 v24, 16, v60
    v_and_b32 v25, 0xffff0000, v60
    v_lshlrev_b32 v26, 16, v61
    v_and_b32 v27, 0xffff0000, v61
    v_lshlrev_b32 v28, 16, v62
    v_and_b32 v29, 0xffff0000, v62
    v_lshlrev_b32 v30, 16, v63
    v_and_b32 v31, 0xffff0000, v63
    v_pk_add_f32 v[16:17], v[16:17], v[24:25]
    v_pk_add_f32 v[18:19], v[18:19], v[26:27]
    v_pk_add_f32 v[20:21], v[20:21], v[28:29]
    v_pk_add_f32 v[22:23], v[22:23], v[30:31]
    s_waitcnt vmcnt(3)
    s_add_u32 s43, s42, 1376256
    buffer_load_dwordx4 v[80:83], v4, s[48:51], s43 offen
    v_lshlrev_b32 v24, 16, v64
    v_and_b32 v25, 0xffff0000, v64
    v_lshlrev_b32 v26, 16, v65
    v_and_b32 v27, 0xffff0000, v65
    v_lshlrev_b32 v28, 16, v66
    v_and_b32 v29, 0xffff0000, v66
    v_lshlrev_b32 v30, 16, v67
    v_and_b32 v31, 0xffff0000, v67
    v_pk_add_f32 v[16:17], v[16:17], v[24:25]
    v_pk_add_f32 v[18:19], v[18:19], v[26:27]
    v_pk_add_f32 v[20:21], v[20:21], v[28:29]
    v_pk_add_f32 v[22:23], v[22:23], v[30:31]
    s_waitcnt vmcnt(3)
    s_add_u32 s43, s42, 1490944
    buffer_load_dwordx4 v[84:87], v4, s[48:51], s43 offen
    v_lshlrev_b32 v24, 16, v68
    v_and_b32 v25, 0xffff0000, v68
    v_lshlrev_b32 v26, 16, v69
    v_and_b32 v27, 0xffff0000, v69
    v_lshlrev_b32 v28, 16, v70
    v_and_b32 v29, 0xffff0000, v70
    v_lshlrev_b32 v30, 16, v71
    v_and_b32 v31, 0xffff0000, v71
    v_pk_add_f32 v[16:17], v[16:17], v[24:25]
    v_pk_add_f32 v[18:19], v[18:19], v[26:27]
    v_pk_add_f32 v[20:21], v[20:21], v[28:29]
    v_pk_add_f32 v[22:23], v[22:23], v[30:31]
    s_waitcnt vmcnt(3)
    v_lshlrev_b32 v24, 16, v72
    v_and_b32 v25, 0xffff0000, v72
    v_lshlrev_b32 v26, 16, v73
    v_and_b32 v27, 0xffff0000, v73
    v_lshlrev_b32 v28, 16, v74
    v_and_b32 v29, 0xffff0000, v74
    v_lshlrev_b32 v30, 16, v75
    v_and_b32 v31, 0xffff0000, v75
    v_pk_add_f32 v[16:17], v[16:17], v[24:25]
    v_pk_add_f32 v[18:19], v[18:19], v[26:27]
    v_pk_add_f32 v[20:21], v[20:21], v[28:29]
    v_pk_add_f32 v[22:23], v[22:23], v[30:31]
    s_waitcnt vmcnt(2)
    v_lshlrev_b32 v24, 16, v76
    v_and_b32 v25, 0xffff0000, v76
    v_lshlrev_b32 v26, 16, v77
    v_and_b32 v27, 0xffff0000, v77
    v_lshlrev_b32 v28, 16, v78
    v_and_b32 v29, 0xffff0000, v78
    v_lshlrev_b32 v30, 16, v79
    v_and_b32 v31, 0xffff0000, v79
    v_pk_add_f32 v[16:17], v[16:17], v[24:25]
    v_pk_add_f32 v[18:19], v[18:19], v[26:27]
    v_pk_add_f32 v[20:21], v[20:21], v[28:29]
    v_pk_add_f32 v[22:23], v[22:23], v[30:31]
    s_waitcnt vmcnt(1)
    v_lshlrev_b32 v24, 16, v80
    v_and_b32 v25, 0xffff0000, v80
    v_lshlrev_b32 v26, 16, v81
    v_and_b32 v27, 0xffff0000, v81
    v_lshlrev_b32 v28, 16, v82
    v_and_b32 v29, 0xffff0000, v82
    v_lshlrev_b32 v30, 16, v83
    v_and_b32 v31, 0xffff0000, v83
    v_pk_add_f32 v[16:17], v[16:17], v[24:25]
    v_pk_add_f32 v[18:19], v[18:19], v[26:27]
    v_pk_add_f32 v[20:21], v[20:21], v[28:29]
    v_pk_add_f32 v[22:23], v[22:23], v[30:31]
    s_waitcnt vmcnt(0)
    v_lshlrev_b32 v24, 16, v84
    v_and_b32 v25, 0xffff0000, v84
    v_lshlrev_b32 v26, 16, v85
    v_and_b32 v27, 0xffff0000, v85
    v_lshlrev_b32 v28, 16, v86
    v_and_b32 v29, 0xffff0000, v86
    v_lshlrev_b32 v30, 16, v87
    v_and_b32 v31, 0xffff0000, v87
    v_pk_add_f32 v[16:17], v[16:17], v[24:25]
    v_pk_add_f32 v[18:19], v[18:19], v[26:27]
    v_pk_add_f32 v[20:21], v[20:21], v[28:29]
    v_pk_add_f32 v[22:23], v[22:23], v[30:31]
    v_lshlrev_b32 v6, 9, v3
    v_lshl_add_u32 v6, v5, 5, v6
    ds_write_b128 v6, v[16:19]
    ds_write_b128 v6, v[20:23] offset:16
    s_waitcnt lgkmcnt(0)
    s_barrier
    s_cmp_ge_u32 s24, 2
    s_cbranch_scc1 L_ka_cs_end
    v_lshlrev_b32 v6, 2, v0
    ds_read_b32 v32, v6 offset:0
    ds_read_b32 v33, v6 offset:512
    ds_read_b32 v34, v6 offset:1024
    ds_read_b32 v35, v6 offset:1536
    ds_read_b32 v36, v6 offset:2048
    ds_read_b32 v37, v6 offset:2560
    ds_read_b32 v38, v6 offset:3072
    ds_read_b32 v39, v6 offset:3584
    s_waitcnt lgkmcnt(0)
    ds_read_b32 v40, v6 offset:4096
    ds_read_b32 v41, v6 offset:4608
    ds_read_b32 v42, v6 offset:5120
    ds_read_b32 v43, v6 offset:5632
    ds_read_b32 v44, v6 offset:6144
    ds_read_b32 v45, v6 offset:6656
    ds_read_b32 v46, v6 offset:7168
    ds_read_b32 v47, v6 offset:7680
    s_waitcnt lgkmcnt(0)
    ds_read_b32 v48, v6 offset:8192
    ds_read_b32 v49, v6 offset:8704
    ds_read_b32 v50, v6 offset:9216
    ds_read_b32 v51, v6 offset:9728
    ds_read_b32 v52, v6 offset:10240
    ds_read_b32 v53, v6 offset:10752
    ds_read_b32 v54, v6 offset:11264
    ds_read_b32 v55, v6 offset:11776
    s_waitcnt lgkmcnt(0)
    ds_read_b32 v56, v6 offset:12288
    ds_read_b32 v57, v6 offset:12800
    ds_read_b32 v58, v6 offset:13312
    ds_read_b32 v59, v6 offset:13824
    ds_read_b32 v60, v6 offset:14336
    ds_read_b32 v61, v6 offset:14848
    ds_read_b32 v62, v6 offset:15360
    ds_read_b32 v63, v6 offset:15872
    s_waitcnt lgkmcnt(0)
    v_mov_b32 v16, 0
    v_mov_b32 v17, 0
    v_pk_add_f32 v[16:17], v[16:17], v[32:33]
    v_pk_add_f32 v[16:17], v[16:17], v[34:35]
    v_pk_add_f32 v[16:17], v[16:17], v[36:37]
    v_pk_add_f32 v[16:17], v[16:17], v[38:39]
    v_pk_add_f32 v[16:17], v[16:17], v[40:41]
    v_pk_add_f32 v[16:17], v[16:17], v[42:43]
    v_pk_add_f32 v[16:17], v[16:17], v[44:45]
    v_pk_add_f32 v[16:17], v[16:17], v[46:47]
    v_pk_add_f32 v[16:17], v[16:17], v[48:49]
    v_pk_add_f32 v[16:17], v[16:17], v[50:51]
    v_pk_add_f32 v[16:17], v[16:17], v[52:53]
    v_pk_add_f32 v[16:17], v[16:17], v[54:55]
    v_pk_add_f32 v[16:17], v[16:17], v[56:57]
    v_pk_add_f32 v[16:17], v[16:17], v[58:59]
    v_pk_add_f32 v[16:17], v[16:17], v[60:61]
    v_pk_add_f32 v[16:17], v[16:17], v[62:63]
    v_add_f32 v16, v16, v17
    s_mul_i32 s42, s37, 7168
    s_lshl_b32 s43, s38, 9
    s_add_u32 s42, s42, s43
    buffer_store_dword v16, v6, s[52:55], s42 offen
L_ka_cs_end:
L_ka_end:
    s_endpgm
.globl kb_kernel
.p2align 8
.type kb_kernel,@function
kb_kernel:
    s_cmp_ge_u32 s2, 256
    s_cbranch_scc1 L_kb_end
    s_load_dwordx16 s[4:19], s[0:1], 0
    s_load_dwordx4 s[20:23], s[0:1], 64
    v_and_b32 v1, 63, v0
    v_lshrrev_b32 v2, 6, v0
    s_and_b32 s25, s2, 7
    v_readfirstlane_b32 s24, v2
    s_lshr_b32 s26, s2, 3
    s_mul_hi_u32 s92, s26, 613566757
    s_mul_i32 s93, s92, 7
    s_sub_u32 s89, s26, s93
    s_lshl_b32 s88, s25, 2
    s_add_u32 s88, s88, s92
    s_getreg_b32 s3, hwreg(HW_REG_XCC_ID)
    s_lshr_b32 s36, s26, 1
    s_and_b32 s38, s26, 1
    s_lshl_b32 s37, s25, 1
    s_add_u32 s37, s37, s38
    s_mul_i32 s40, s36, 7
    s_lshr_b32 s40, s40, 1
    s_and_b32 s41, s36, 1
    v_and_b32 v3, 15, v1
    v_lshrrev_b32 v4, 4, v1
    v_lshlrev_b32 v5, 9, v4
    v_lshl_add_u32 v6, v3, 4, v5
    v_and_b32 v7, 1, v4
    v_lshlrev_b32 v7, 3, v7
    v_xor_b32 v7, v7, v3
    v_lshl_add_u32 v7, v7, 4, v5
    s_lshl_b32 s42, s37, 3
    s_add_u32 s42, s42, s24
    s_lshr_b32 s43, s42, 1
    s_mul_i32 s43, s43, 114688
    s_and_b32 s44, s42, 1
    s_lshl_b32 s44, s44, 8
    s_add_u32 s43, s43, s44
    s_lshl_b32 s45, s40, 9
    s_add_u32 s46, s43, s45
    s_mul_i32 s56, s24, 3
    s_add_u32 s56, s56, 0
    s_lshl_b32 s57, s37, 3
    s_add_u32 s57, s57, s56
    s_sub_u32 s57, s57, 16
    s_lshr_b32 s58, s57, 1
    s_mul_i32 s58, s58, 114688
    s_and_b32 s59, s57, 1
    s_lshl_b32 s59, s59, 8
    s_add_u32 s58, s58, s59
    s_add_u32 s58, s58, s45
    s_cmp_lt_i32 s57, 0
    s_cselect_b32 s58, 0x40000000, s58
    s_add_u32 s66, s58, 28672
    s_add_u32 s67, s58, 57344
    s_mul_i32 s56, s24, 3
    s_add_u32 s56, s56, 1
    s_lshl_b32 s57, s37, 3
    s_add_u32 s57, s57, s56
    s_sub_u32 s57, s57, 16
    s_lshr_b32 s58, s57, 1
    s_mul_i32 s58, s58, 114688
    s_and_b32 s59, s57, 1
    s_lshl_b32 s59, s59, 8
    s_add_u32 s58, s58, s59
    s_add_u32 s58, s58, s45
    s_cmp_lt_i32 s57, 0
    s_cselect_b32 s58, 0x40000000, s58
    s_add_u32 s68, s58, 28672
    s_add_u32 s69, s58, 57344
    s_mul_i32 s56, s24, 3
    s_add_u32 s56, s56, 2
    s_lshl_b32 s57, s37, 3
    s_add_u32 s57, s57, s56
    s_sub_u32 s57, s57, 16
    s_lshr_b32 s58, s57, 1
    s_mul_i32 s58, s58, 114688
    s_and_b32 s59, s57, 1
    s_lshl_b32 s59, s59, 8
    s_add_u32 s58, s58, s59
    s_add_u32 s58, s58, s45
    s_cmp_lt_i32 s57, 0
    s_cselect_b32 s58, 0x40000000, s58
    s_add_u32 s70, s58, 28672
    s_add_u32 s71, s58, 57344
    s_mul_i32 s60, s24, 3072
    s_add_u32 s60, s60, 114688
    s_and_b32 s3, s3, 15
    s_add_u32 s3, s3, 1
    s_waitcnt lgkmcnt(0)
    s_add_u32 s48, s22, 10485760
    s_addc_u32 s49, s23, 0
    s_and_b32 s49, s49, 0xffff
    s_mov_b32 s50, 7340032
    s_mov_b32 s51, 0x00020000
    buffer_load_dwordx4 v[12:15], v6, s[48:51], s46 offen sc1
    s_add_u32 m0, s60, 0
    s_nop 0
    buffer_load_dwordx4 v6, s[48:51], s66 offen sc1 lds
    s_add_u32 m0, s60, 1024
    s_nop 0
    buffer_load_dwordx4 v6, s[48:51], s68 offen sc1 lds
    s_add_u32 m0, s60, 2048
    s_nop 0
    buffer_load_dwordx4 v6, s[48:51], s70 offen sc1 lds
    s_add_u32 m0, s60, 24576
    s_nop 0
    buffer_load_dwordx4 v7, s[48:51], s67 offen sc1 lds
    s_add_u32 m0, s60, 25600
    s_nop 0
    buffer_load_dwordx4 v7, s[48:51], s69 offen sc1 lds
    s_add_u32 m0, s60, 26624
    s_nop 0
    buffer_load_dwordx4 v7, s[48:51], s71 offen sc1 lds
    s_add_u32 s28, s22, 19922944
    s_addc_u32 s29, s23, 0
    s_and_b32 s29, s29, 0xffff
    s_mov_b32 s30, 8192
    s_mov_b32 s31, 0x00020000
    s_lshl_b32 s74, s25, 7
    s_lshl_b32 s56, s26, 2
    s_add_u32 s56, s56, s74
    s_cmp_eq_u32 s24, 7
    s_cselect_b32 s56, s56, 0x40000000
    v_mov_b32 v2, s3
    v_mov_b32 v8, 0
    s_mov_b64 exec, 1
    buffer_store_dword v2, v8, s[28:31], s56 offen sc1
    s_mov_b64 exec, -1
    v_lshlrev_b32 v8, 2, v4
    v_mov_b32 v9, 4048155338
    v_add_u32 v10, 0, v8
    v_cmp_lt_u32 vcc, v3, v10
    s_nop 1
    v_cndmask_b32_e64 v16, v9, 0, vcc
    v_cndmask_b32_e64 v20, 0, v9, vcc
    v_add_u32 v10, 1, v8
    v_cmp_lt_u32 vcc, v3, v10
    s_nop 1
    v_cndmask_b32_e64 v17, v9, 0, vcc
    v_cndmask_b32_e64 v21, 0, v9, vcc
    v_add_u32 v10, 2, v8
    v_cmp_lt_u32 vcc, v3, v10
    s_nop 1
    v_cndmask_b32_e64 v18, v9, 0, vcc
    v_cndmask_b32_e64 v22, 0, v9, vcc
    v_add_u32 v10, 3, v8
    v_cmp_lt_u32 vcc, v3, v10
    s_nop 1
    v_cndmask_b32_e64 v19, v9, 0, vcc
    v_cndmask_b32_e64 v23, 0, v9, vcc
    v_lshlrev_b32 v251, 4, v1
    v_lshlrev_b32 v250, 2, v1
    s_lshl_b32 s95, s24, 10
    s_add_u32 s47, s95, 114688
    v_add_u32 v10, s47, v251
    v_bfe_u32 v24, v1, 2, 2
    v_add_u32 v24, v24, v8
    v_bfe_u32 v25, v1, 1, 1
    v_lshlrev_b32 v26, 3, v25
    v_xor_b32 v24, v24, v26
    v_lshlrev_b32 v24, 4, v24
    v_lshl_add_u32 v24, v25, 8, v24
    v_and_b32 v25, 1, v1
    v_lshl_add_u32 v24, v25, 3, v24
    v_add_u32 v24, 24576, v24
    v_add_u32 v11, s47, v24
    v_lshrrev_b32 v28, 1, v4
    v_lshlrev_b32 v28, 9, v28
    v_lshl_add_u32 v28, v3, 4, v28
    v_and_b32 v29, 1, v4
    v_lshl_add_u32 v28, v29, 3, v28
    v_add_u32 v29, 1024, v28
    v_mov_b32 v30, 0x40000000
    s_cmp_eq_u32 s41, 0
    s_cselect_b32 s62, 64, 0
    s_cselect_b32 s63, 3, 64
    v_cmp_eq_u32 vcc, s62, v4
    s_nop 1
    v_cndmask_b32 v28, v28, v30, vcc
    v_cmp_eq_u32 vcc, s63, v4
    s_nop 1
    v_cndmask_b32 v29, v29, v30, vcc
    s_lshl_b32 s33, s37, 4
    s_add_u32 s33, s33, s36
    s_lshl_b32 s33, s33, 2
    s_add_u32 s33, s33, 1024
    v_lshrrev_b32 v254, 3, v1
    v_mul_u32_u24 v150, 3584, v254
    v_mul_u32_u24 v254, 896, v254
    v_bfe_u32 v151, v1, 2, 1
    v_bfe_u32 v152, v1, 4, 1
    v_xor_b32 v151, v151, v152
    v_lshl_add_u32 v254, v151, 6, v254
    v_and_b32 v151, 3, v1
    v_lshl_add_u32 v254, v151, 4, v254
    v_bfe_u32 v151, v1, 1, 2
    v_xor_b32 v151, v151, v152
    v_and_b32 v152, 1, v1
    v_lshl_add_u32 v150, v152, 4, v150
    v_lshl_add_u32 v252, v151, 5, v150
    v_xor_b32 v151, 2, v151
    v_lshl_add_u32 v253, v151, 5, v150
    s_mov_b32 s80, s12
    s_mov_b32 s81, s13
    s_and_b32 s81, s81, 0xffff
    s_mov_b32 s82, 1605632
    s_mov_b32 s83, 0x00020000
    s_mov_b32 s84, s14
    s_mov_b32 s85, s15
    s_and_b32 s85, s85, 0xffff
    s_mov_b32 s86, 1605632
    s_mov_b32 s87, 0x00020000
    s_mov_b32 s96, s8
    s_mov_b32 s97, s9
    s_and_b32 s97, s97, 0xffff
    s_mov_b32 s98, 401408
    s_mov_b32 s99, 0x00020000
    s_mul_i32 s94, s24, 28672
    s_lshl_b32 s56, s26, 7
    s_add_u32 s94, s94, s56
    s_mul_i32 s78, s24, 7168
    s_lshl_b32 s56, s89, 7
    s_add_u32 s78, s78, s56
    s_lshl_b32 s56, s92, 1
    s_add_u32 s77, s89, s56
    s_sub_u32 s100, s77, 7
    s_cmp_ge_u32 s77, 7
    s_cselect_b32 s77, s100, s77
    s_mul_i32 s56, s92, 7
    s_lshl_b32 s57, s89, 2
    s_add_u32 s93, s57, s56
    s_sub_u32 s100, s93, 28
    s_cmp_ge_u32 s93, 28
    s_cselect_b32 s93, s100, s93
    s_cmp_ge_u32 s26, 28
    s_cselect_b32 s94, 0x40000000, s94
    s_cselect_b32 s78, 0x40000000, s78
    s_mul_i32 s90, s89, 229376
    s_add_u32 s90, s90, s94
    s_add_u32 s91, s94, 1605632
    s_mul_i32 s79, s77, 57344
    s_add_u32 s79, s79, s78
    s_add_u32 s75, s78, 401408
    s_and_b32 s56, s24, 3
    s_lshr_b32 s57, s24, 2
    s_lshl_b32 s58, s88, 1
    s_add_u32 s58, s58, s57
    s_mul_i32 s58, s58, 28672
    s_lshl_b32 s59, s89, 7
    s_add_u32 s58, s58, s59
    s_lshl_b32 s59, s56, 5
    s_add_u32 s73, s58, s59
    s_cmp_ge_u32 s26, 28
    s_cselect_b32 s73, 0x40000000, s73
    v_and_b32 v150, 31, v1
    v_mul_u32_u24 v150, 896, v150
    v_lshrrev_b32 v151, 5, v1
    v_lshl_add_u32 v249, v151, 4, v150
    s_mov_b32 s56, s4
    s_mov_b32 s57, s5
    s_and_b32 s57, s57, 0xffff
    s_mov_b32 s58, 1835008
    s_mov_b32 s59, 0x00020000
    s_waitcnt vmcnt(7)
    s_cmp_eq_u32 s41, 0
    s_cbranch_scc0 L_kb_p2_odd
    v_cmp_gt_u32 vcc, 48, v1
    s_nop 1
    v_cndmask_b32 v14, 0, v14, vcc
    v_cndmask_b32 v15, 0, v15, vcc
    s_branch L_kb_p2_qd
L_kb_p2_odd:
    v_cmp_le_u32 vcc, 16, v1
    s_nop 1
    v_cndmask_b32 v12, 0, v12, vcc
    v_cndmask_b32 v13, 0, v13, vcc
L_kb_p2_qd:
    s_waitcnt vmcnt(1)
    s_barrier
    s_add_u32 s68, s22, 8388608
    s_addc_u32 s69, s23, 0
    s_and_b32 s69, s69, 0xffff
    s_mov_b32 s70, 1835008
    s_mov_b32 s71, 0x00020000
    s_lshr_b32 s66, s24, 2
    s_lshl_b32 s67, s88, 1
    s_add_u32 s66, s66, s67
    s_mul_i32 s67, s66, 28672
    s_lshl_b32 s72, s89, 12
    s_add_u32 s67, s67, s72
    s_and_b32 s72, s24, 3
    s_lshl_b32 s72, s72, 10
    s_add_u32 s67, s67, s72
    s_cmp_ge_u32 s26, 28
    s_cselect_b32 s67, 0x40000000, s67
    buffer_load_dwordx4 v[144:147], v251, s[68:71], s67 offen sc1
    s_add_u32 s68, s22, 18939904
    s_addc_u32 s69, s23, 0
    s_and_b32 s69, s69, 0xffff
    s_mov_b32 s70, 114688
    s_mov_b32 s71, 0x00020000
    s_mul_i32 s67, s89, 16384
    s_lshl_b32 s66, s66, 8
    s_add_u32 s67, s67, s66
    buffer_load_dword v148, v250, s[68:71], s67 offen sc1
    s_add_u32 s68, s22, 18874368
    s_addc_u32 s69, s23, 0
    s_and_b32 s69, s69, 0xffff
    s_mov_b32 s70, 14336
    s_mov_b32 s71, 0x00020000
    s_mul_i32 s66, s24, 7168
    s_lshl_b32 s67, s26, 8
    s_add_u32 s66, s66, s67
    s_min_u32 s67, s24, 2
    s_lshl_b32 s67, s67, 8
    s_add_u32 m0, s67, 49152
    s_nop 0
    buffer_load_dword v250, s[68:71], s66 offen sc1 lds
    ds_read_b128 v[100:103], v10 offset:0
    ds_read_b128 v[104:107], v10 offset:1024
    ds_read_b128 v[108:111], v10 offset:2048
    ds_read_b128 v[112:115], v10 offset:3072
    ds_read_b128 v[116:119], v10 offset:4096
    ds_read_b128 v[120:123], v10 offset:5120
    s_waitcnt lgkmcnt(5)
    v_mfma_f32_16x16x32_bf16 v[32:35], v[100:103], v[12:15], v[16:19]
    ds_read_b128 v[100:103], v10 offset:6144
    s_waitcnt lgkmcnt(5)
    v_mfma_f32_16x16x32_bf16 v[36:39], v[104:107], v[12:15], 0
    ds_read_b128 v[104:107], v10 offset:7168
    s_waitcnt lgkmcnt(5)
    v_mfma_f32_16x16x32_bf16 v[40:43], v[108:111], v[12:15], 0
    ds_read_b128 v[108:111], v10 offset:8192
    s_add_u32 m0, s95, 57344
    s_add_u32 s92, s79, 57344
    buffer_load_dwordx4 v254, s[96:99], s79 offen lds
    s_cmp_eq_u32 s92, s75
    s_cselect_b32 s79, s78, s92
    s_waitcnt lgkmcnt(5)
    v_mfma_f32_16x16x32_bf16 v[44:47], v[112:115], v[12:15], 0
    ds_read_b128 v[112:115], v10 offset:9216
    s_waitcnt lgkmcnt(5)
    v_mfma_f32_16x16x32_bf16 v[48:51], v[116:119], v[12:15], 0
    ds_read_b128 v[116:119], v10 offset:10240
    s_waitcnt lgkmcnt(5)
    v_mfma_f32_16x16x32_bf16 v[52:55], v[120:123], v[12:15], 0
    ds_read_b128 v[120:123], v10 offset:11264
    s_add_u32 m0, s95, 65536
    s_add_u32 s92, s79, 57344
    buffer_load_dwordx4 v254, s[96:99], s79 offen lds
    s_cmp_eq_u32 s92, s75
    s_cselect_b32 s79, s78, s92
    s_waitcnt lgkmcnt(5)
    v_mfma_f32_16x16x32_bf16 v[56:59], v[100:103], v[12:15], 0
    ds_read_b128 v[100:103], v10 offset:12288
    s_waitcnt lgkmcnt(5)
    v_mfma_f32_16x16x32_bf16 v[60:63], v[104:107], v[12:15], 0
    ds_read_b128 v[104:107], v10 offset:13312
    s_waitcnt lgkmcnt(5)
    v_mfma_f32_16x16x32_bf16 v[64:67], v[108:111], v[12:15], 0
    ds_read_b128 v[108:111], v10 offset:14336
    s_add_u32 m0, s95, 73728
    s_add_u32 s92, s79, 57344
    buffer_load_dwordx4 v254, s[96:99], s79 offen lds
    s_cmp_eq_u32 s92, s75
    s_cselect_b32 s79, s78, s92
    s_waitcnt lgkmcnt(5)
    v_mfma_f32_16x16x32_bf16 v[68:71], v[112:115], v[12:15], 0
    ds_read_b128 v[112:115], v10 offset:15360
    s_waitcnt lgkmcnt(5)
    v_mfma_f32_16x16x32_bf16 v[72:75], v[116:119], v[12:15], 0
    ds_read_b128 v[116:119], v10 offset:16384
    s_waitcnt lgkmcnt(5)
    v_mfma_f32_16x16x32_bf16 v[76:79], v[120:123], v[12:15], 0
    s_add_u32 m0, s95, 81920
    s_add_u32 s92, s79, 57344
    buffer_load_dwordx4 v254, s[96:99], s79 offen lds
    s_cmp_eq_u32 s92, s75
    s_cselect_b32 s79, s78, s92
    s_waitcnt lgkmcnt(4)
    v_mfma_f32_16x16x32_bf16 v[80:83], v[100:103], v[12:15], 0
    s_waitcnt lgkmcnt(3)
    v_mfma_f32_16x16x32_bf16 v[84:87], v[104:107], v[12:15], 0
    s_waitcnt lgkmcnt(2)
    v_mfma_f32_16x16x32_bf16 v[88:91], v[108:111], v[12:15], 0
    s_add_u32 m0, s95, 90112
    s_add_u32 s92, s79, 57344
    buffer_load_dwordx4 v254, s[96:99], s79 offen lds
    s_cmp_eq_u32 s92, s75
    s_cselect_b32 s79, s78, s92
    s_waitcnt lgkmcnt(1)
    v_mfma_f32_16x16x32_bf16 v[92:95], v[112:115], v[12:15], 0
    s_waitcnt lgkmcnt(0)
    v_mfma_f32_16x16x32_bf16 v[96:99], v[116:119], v[12:15], v[20:23]
    ds_read_b64_tr_b16 v[100:101], v11 offset:0
    ds_read_b64_tr_b16 v[102:103], v11 offset:1024
    ds_read_b64_tr_b16 v[104:105], v11 offset:512
    ds_read_b64_tr_b16 v[106:107], v11 offset:1536
    ds_read_b64_tr_b16 v[108:109], v11 offset:2048
    ds_read_b64_tr_b16 v[110:111], v11 offset:3072
    ds_read_b64_tr_b16 v[112:113], v11 offset:2560
    ds_read_b64_tr_b16 v[114:115], v11 offset:3584
    ds_read_b64_tr_b16 v[116:117], v11 offset:4096
    ds_read_b64_tr_b16 v[118:119], v11 offset:5120
    ds_read_b64_tr_b16 v[120:121], v11 offset:4608
    ds_read_b64_tr_b16 v[122:123], v11 offset:5632
    s_cmp_ge_u32 s42, 16
    s_cbranch_scc1 L_kb_p2_nomask
    s_sub_u32 s63, 16, s42
    s_cmp_le_u32 s63, 0
    s_cbranch_scc1 L_kb_p2_nomask
    v_mov_b32 v32, v9
    v_mov_b32 v33, v9
    v_mov_b32 v34, v9
    v_mov_b32 v35, v9
    s_cmp_le_u32 s63, 1
    s_cbranch_scc1 L_kb_p2_nomask
    v_mov_b32 v36, v9
    v_mov_b32 v37, v9
    v_mov_b32 v38, v9
    v_mov_b32 v39, v9
    s_cmp_le_u32 s63, 2
    s_cbranch_scc1 L_kb_p2_nomask
    v_mov_b32 v40, v9
    v_mov_b32 v41, v9
    v_mov_b32 v42, v9
    v_mov_b32 v43, v9
    s_cmp_le_u32 s63, 3
    s_cbranch_scc1 L_kb_p2_nomask
    v_mov_b32 v44, v9
    v_mov_b32 v45, v9
    v_mov_b32 v46, v9
    v_mov_b32 v47, v9
    s_cmp_le_u32 s63, 4
    s_cbranch_scc1 L_kb_p2_nomask
    v_mov_b32 v48, v9
    v_mov_b32 v49, v9
    v_mov_b32 v50, v9
    v_mov_b32 v51, v9
    s_cmp_le_u32 s63, 5
    s_cbranch_scc1 L_kb_p2_nomask
    v_mov_b32 v52, v9
    v_mov_b32 v53, v9
    v_mov_b32 v54, v9
    v_mov_b32 v55, v9
    s_cmp_le_u32 s63, 6
    s_cbranch_scc1 L_kb_p2_nomask
    v_mov_b32 v56, v9
    v_mov_b32 v57, v9
    v_mov_b32 v58, v9
    v_mov_b32 v59, v9
    s_cmp_le_u32 s63, 7
    s_cbranch_scc1 L_kb_p2_nomask
    v_mov_b32 v60, v9
    v_mov_b32 v61, v9
    v_mov_b32 v62, v9
    v_mov_b32 v63, v9
    s_cmp_le_u32 s63, 8
    s_cbranch_scc1 L_kb_p2_nomask
    v_mov_b32 v64, v9
    v_mov_b32 v65, v9
    v_mov_b32 v66, v9
    v_mov_b32 v67, v9
    s_cmp_le_u32 s63, 9
    s_cbranch_scc1 L_kb_p2_nomask
    v_mov_b32 v68, v9
    v_mov_b32 v69, v9
    v_mov_b32 v70, v9
    v_mov_b32 v71, v9
    s_cmp_le_u32 s63, 10
    s_cbranch_scc1 L_kb_p2_nomask
    v_mov_b32 v72, v9
    v_mov_b32 v73, v9
    v_mov_b32 v74, v9
    v_mov_b32 v75, v9
    s_cmp_le_u32 s63, 11
    s_cbranch_scc1 L_kb_p2_nomask
    v_mov_b32 v76, v9
    v_mov_b32 v77, v9
    v_mov_b32 v78, v9
    v_mov_b32 v79, v9
    s_cmp_le_u32 s63, 12
    s_cbranch_scc1 L_kb_p2_nomask
    v_mov_b32 v80, v9
    v_mov_b32 v81, v9
    v_mov_b32 v82, v9
    v_mov_b32 v83, v9
    s_cmp_le_u32 s63, 13
    s_cbranch_scc1 L_kb_p2_nomask
    v_mov_b32 v84, v9
    v_mov_b32 v85, v9
    v_mov_b32 v86, v9
    v_mov_b32 v87, v9
    s_cmp_le_u32 s63, 14
    s_cbranch_scc1 L_kb_p2_nomask
    v_mov_b32 v88, v9
    v_mov_b32 v89, v9
    v_mov_b32 v90, v9
    v_mov_b32 v91, v9
    s_cmp_le_u32 s63, 15
    s_cbranch_scc1 L_kb_p2_nomask
    v_mov_b32 v92, v9
    v_mov_b32 v93, v9
    v_mov_b32 v94, v9
    v_mov_b32 v95, v9
L_kb_p2_nomask:
    v_max3_f32 v24, v32, v33, v34
    v_max3_f32 v25, v35, v36, v37
    v_max3_f32 v24, v24, v38, v39
    v_max3_f32 v25, v25, v40, v41
    v_max3_f32 v24, v24, v42, v43
    v_max3_f32 v25, v25, v44, v45
    v_max3_f32 v24, v24, v46, v47
    v_max3_f32 v25, v25, v48, v49
    v_max3_f32 v24, v24, v50, v51
    v_max3_f32 v25, v25, v52, v53
    v_max3_f32 v24, v24, v54, v55
    v_max3_f32 v25, v25, v56, v57
    v_max3_f32 v24, v24, v58, v59
    v_max3_f32 v25, v25, v60, v61
    v_max3_f32 v24, v24, v62, v63
    v_max3_f32 v25, v25, v64, v65
    v_max3_f32 v24, v24, v66, v67
    v_max3_f32 v25, v25, v68, v69
    v_max3_f32 v24, v24, v70, v71
    v_max3_f32 v25, v25, v72, v73
    v_max3_f32 v24, v24, v74, v75
    v_max3_f32 v25, v25, v76, v77
    v_max3_f32 v24, v24, v78, v79
    v_max3_f32 v25, v25, v80, v81
    v_max3_f32 v24, v24, v82, v83
    v_max3_f32 v25, v25, v84, v85
    v_max3_f32 v24, v24, v86, v87
    v_max3_f32 v25, v25, v88, v89
    v_max3_f32 v24, v24, v90, v91
    v_max3_f32 v25, v25, v92, v93
    v_max3_f32 v24, v24, v94, v95
    v_max3_f32 v25, v25, v96, v97
    v_max3_f32 v24, v24, v98, v99
    v_max_f32 v24, v24, v25
    v_mov_b32 v25, v24
    s_nop 1
    v_permlane32_swap_b32 v24, v25
    v_max_f32 v24, v24, v25
    v_mov_b32 v25, v24
    s_nop 1
    v_permlane16_swap_b32 v24, v25
    v_max_f32 v24, v24, v25
    v_mov_b32 v25, v24
    v_mov_b32 v26, 0
    v_mov_b32 v27, 0
    v_pk_add_f32 v[32:33], v[32:33], v[24:25] neg_lo:[0,1] neg_hi:[0,1]
    v_pk_add_f32 v[34:35], v[34:35], v[24:25] neg_lo:[0,1] neg_hi:[0,1]
    v_pk_add_f32 v[36:37], v[36:37], v[24:25] neg_lo:[0,1] neg_hi:[0,1]
    v_pk_add_f32 v[38:39], v[38:39], v[24:25] neg_lo:[0,1] neg_hi:[0,1]
    v_exp_f32 v32, v32
    v_exp_f32 v33, v33
    v_exp_f32 v34, v34
    v_exp_f32 v35, v35
    v_exp_f32 v36, v36
    v_exp_f32 v37, v37
    v_exp_f32 v38, v38
    v_exp_f32 v39, v39
    s_add_u32 m0, s95, 98304
    s_add_u32 s92, s79, 57344
    buffer_load_dwordx4 v254, s[96:99], s79 offen lds
    s_cmp_eq_u32 s92, s75
    s_cselect_b32 s79, s78, s92
    v_cvt_pk_bf16_f32 v132, v32, v33
    v_cvt_pk_bf16_f32 v133, v34, v35
    v_cvt_pk_bf16_f32 v134, v36, v37
    v_cvt_pk_bf16_f32 v135, v38, v39
    v_pk_add_f32 v[26:27], v[26:27], v[32:33]
    v_pk_add_f32 v[26:27], v[26:27], v[34:35]
    v_pk_add_f32 v[26:27], v[26:27], v[36:37]
    v_pk_add_f32 v[26:27], v[26:27], v[38:39]
    s_waitcnt lgkmcnt(8)
    v_mfma_f32_16x16x32_bf16 v[124:127], v[100:103], v[132:135], 0
    v_mfma_f32_16x16x32_bf16 v[128:131], v[104:107], v[132:135], 0
    ds_read_b64_tr_b16 v[100:101], v11 offset:6144
    ds_read_b64_tr_b16 v[102:103], v11 offset:7168
    ds_read_b64_tr_b16 v[104:105], v11 offset:6656
    ds_read_b64_tr_b16 v[106:107], v11 offset:7680
    v_pk_add_f32 v[40:41], v[40:41], v[24:25] neg_lo:[0,1] neg_hi:[0,1]
    v_pk_add_f32 v[42:43], v[42:43], v[24:25] neg_lo:[0,1] neg_hi:[0,1]
    v_pk_add_f32 v[44:45], v[44:45], v[24:25] neg_lo:[0,1] neg_hi:[0,1]
    v_pk_add_f32 v[46:47], v[46:47], v[24:25] neg_lo:[0,1] neg_hi:[0,1]
    v_exp_f32 v40, v40
    v_exp_f32 v41, v41
    v_exp_f32 v42, v42
    v_exp_f32 v43, v43
    v_exp_f32 v44, v44
    v_exp_f32 v45, v45
    v_exp_f32 v46, v46
    v_exp_f32 v47, v47
    s_add_u32 m0, s95, 106496
    s_add_u32 s92, s79, 57344
    buffer_load_dwordx4 v254, s[96:99], s79 offen lds
    s_cmp_eq_u32 s92, s75
    s_cselect_b32 s79, s78, s92
    v_cvt_pk_bf16_f32 v136, v40, v41
    v_cvt_pk_bf16_f32 v137, v42, v43
    v_cvt_pk_bf16_f32 v138, v44, v45
    v_cvt_pk_bf16_f32 v139, v46, v47
    v_pk_add_f32 v[26:27], v[26:27], v[40:41]
    v_pk_add_f32 v[26:27], v[26:27], v[42:43]
    v_pk_add_f32 v[26:27], v[26:27], v[44:45]
    v_pk_add_f32 v[26:27], v[26:27], v[46:47]
    s_waitcnt lgkmcnt(8)
    v_mfma_f32_16x16x32_bf16 v[124:127], v[108:111], v[136:139], v[124:127]
    v_mfma_f32_16x16x32_bf16 v[128:131], v[112:115], v[136:139], v[128:131]
    ds_read_b64_tr_b16 v[108:109], v11 offset:8192
    ds_read_b64_tr_b16 v[110:111], v11 offset:9216
    ds_read_b64_tr_b16 v[112:113], v11 offset:8704
    ds_read_b64_tr_b16 v[114:115], v11 offset:9728
    v_pk_add_f32 v[48:49], v[48:49], v[24:25] neg_lo:[0,1] neg_hi:[0,1]
    v_pk_add_f32 v[50:51], v[50:51], v[24:25] neg_lo:[0,1] neg_hi:[0,1]
    v_pk_add_f32 v[52:53], v[52:53], v[24:25] neg_lo:[0,1] neg_hi:[0,1]
    v_pk_add_f32 v[54:55], v[54:55], v[24:25] neg_lo:[0,1] neg_hi:[0,1]
    v_exp_f32 v48, v48
    v_exp_f32 v49, v49
    v_exp_f32 v50, v50
    v_exp_f32 v51, v51
    v_exp_f32 v52, v52
    v_exp_f32 v53, v53
    v_exp_f32 v54, v54
    v_exp_f32 v55, v55
    buffer_load_dwordx4 v[240:243], v249, s[56:59], s73 offen
    v_cvt_pk_bf16_f32 v132, v48, v49
    v_cvt_pk_bf16_f32 v133, v50, v51
    v_cvt_pk_bf16_f32 v134, v52, v53
    v_cvt_pk_bf16_f32 v135, v54, v55
    v_pk_add_f32 v[26:27], v[26:27], v[48:49]
    v_pk_add_f32 v[26:27], v[26:27], v[50:51]
    v_pk_add_f32 v[26:27], v[26:27], v[52:53]
    v_pk_add_f32 v[26:27], v[26:27], v[54:55]
    s_waitcnt lgkmcnt(8)
    v_mfma_f32_16x16x32_bf16 v[124:127], v[116:119], v[132:135], v[124:127]
    v_mfma_f32_16x16x32_bf16 v[128:131], v[120:123], v[132:135], v[128:131]
    ds_read_b64_tr_b16 v[116:117], v11 offset:10240
    ds_read_b64_tr_b16 v[118:119], v11 offset:11264
    ds_read_b64_tr_b16 v[120:121], v11 offset:10752
    ds_read_b64_tr_b16 v[122:123], v11 offset:11776
    v_pk_add_f32 v[56:57], v[56:57], v[24:25] neg_lo:[0,1] neg_hi:[0,1]
    v_pk_add_f32 v[58:59], v[58:59], v[24:25] neg_lo:[0,1] neg_hi:[0,1]
    v_pk_add_f32 v[60:61], v[60:61], v[24:25] neg_lo:[0,1] neg_hi:[0,1]
    v_pk_add_f32 v[62:63], v[62:63], v[24:25] neg_lo:[0,1] neg_hi:[0,1]
    v_exp_f32 v56, v56
    v_exp_f32 v57, v57
    v_exp_f32 v58, v58
    v_exp_f32 v59, v59
    v_exp_f32 v60, v60
    v_exp_f32 v61, v61
    v_exp_f32 v62, v62
    v_exp_f32 v63, v63
    s_add_u32 m0, s95, 0
    s_nop 0
    buffer_load_dwordx4 v252, s[80:83], s90 offen lds
    v_cvt_pk_bf16_f32 v136, v56, v57
    v_cvt_pk_bf16_f32 v137, v58, v59
    v_cvt_pk_bf16_f32 v138, v60, v61
    v_cvt_pk_bf16_f32 v139, v62, v63
    v_pk_add_f32 v[26:27], v[26:27], v[56:57]
    v_pk_add_f32 v[26:27], v[26:27], v[58:59]
    v_pk_add_f32 v[26:27], v[26:27], v[60:61]
    v_pk_add_f32 v[26:27], v[26:27], v[62:63]
    s_waitcnt lgkmcnt(8)
    v_mfma_f32_16x16x32_bf16 v[124:127], v[100:103], v[136:139], v[124:127]
    v_mfma_f32_16x16x32_bf16 v[128:131], v[104:107], v[136:139], v[128:131]
    ds_read_b64_tr_b16 v[100:101], v11 offset:12288
    ds_read_b64_tr_b16 v[102:103], v11 offset:13312
    ds_read_b64_tr_b16 v[104:105], v11 offset:12800
    ds_read_b64_tr_b16 v[106:107], v11 offset:13824
    v_pk_add_f32 v[64:65], v[64:65], v[24:25] neg_lo:[0,1] neg_hi:[0,1]
    v_pk_add_f32 v[66:67], v[66:67], v[24:25] neg_lo:[0,1] neg_hi:[0,1]
    v_pk_add_f32 v[68:69], v[68:69], v[24:25] neg_lo:[0,1] neg_hi:[0,1]
    v_pk_add_f32 v[70:71], v[70:71], v[24:25] neg_lo:[0,1] neg_hi:[0,1]
    v_exp_f32 v64, v64
    v_exp_f32 v65, v65
    v_exp_f32 v66, v66
    v_exp_f32 v67, v67
    v_exp_f32 v68, v68
    v_exp_f32 v69, v69
    v_exp_f32 v70, v70
    v_exp_f32 v71, v71
    s_add_u32 m0, s95, 8192
    s_add_u32 s92, s90, 229376
    buffer_load_dwordx4 v253, s[84:87], s90 offen lds
    s_cmp_eq_u32 s92, s91
    s_cselect_b32 s90, s94, s92
    v_cvt_pk_bf16_f32 v132, v64, v65
    v_cvt_pk_bf16_f32 v133, v66, v67
    v_cvt_pk_bf16_f32 v134, v68, v69
    v_cvt_pk_bf16_f32 v135, v70, v71
    v_pk_add_f32 v[26:27], v[26:27], v[64:65]
    v_pk_add_f32 v[26:27], v[26:27], v[66:67]
    v_pk_add_f32 v[26:27], v[26:27], v[68:69]
    v_pk_add_f32 v[26:27], v[26:27], v[70:71]
    s_waitcnt lgkmcnt(8)
    v_mfma_f32_16x16x32_bf16 v[124:127], v[108:111], v[132:135], v[124:127]
    v_mfma_f32_16x16x32_bf16 v[128:131], v[112:115], v[132:135], v[128:131]
    ds_read_b64_tr_b16 v[108:109], v11 offset:14336
    ds_read_b64_tr_b16 v[110:111], v11 offset:15360
    ds_read_b64_tr_b16 v[112:113], v11 offset:14848
    ds_read_b64_tr_b16 v[114:115], v11 offset:15872
    buffer_load_dword v31, v250, s[28:31], s74 offen sc1
    v_pk_add_f32 v[72:73], v[72:73], v[24:25] neg_lo:[0,1] neg_hi:[0,1]
    v_pk_add_f32 v[74:75], v[74:75], v[24:25] neg_lo:[0,1] neg_hi:[0,1]
    v_pk_add_f32 v[76:77], v[76:77], v[24:25] neg_lo:[0,1] neg_hi:[0,1]
    v_pk_add_f32 v[78:79], v[78:79], v[24:25] neg_lo:[0,1] neg_hi:[0,1]
    v_exp_f32 v72, v72
    v_exp_f32 v73, v73
    v_exp_f32 v74, v74
    v_exp_f32 v75, v75
    v_exp_f32 v76, v76
    v_exp_f32 v77, v77
    v_exp_f32 v78, v78
    v_exp_f32 v79, v79
    s_add_u32 m0, s95, 16384
    s_nop 0
    buffer_load_dwordx4 v252, s[80:83], s90 offen lds
    v_cvt_pk_bf16_f32 v136, v72, v73
    v_cvt_pk_bf16_f32 v137, v74, v75
    v_cvt_pk_bf16_f32 v138, v76, v77
    v_cvt_pk_bf16_f32 v139, v78, v79
    v_pk_add_f32 v[26:27], v[26:27], v[72:73]
    v_pk_add_f32 v[26:27], v[26:27], v[74:75]
    v_pk_add_f32 v[26:27], v[26:27], v[76:77]
    v_pk_add_f32 v[26:27], v[26:27], v[78:79]
    s_waitcnt lgkmcnt(8)
    v_mfma_f32_16x16x32_bf16 v[124:127], v[116:119], v[136:139], v[124:127]
    v_mfma_f32_16x16x32_bf16 v[128:131], v[120:123], v[136:139], v[128:131]
    ds_read_b64_tr_b16 v[116:117], v11 offset:16384
    ds_read_b64_tr_b16 v[120:121], v11 offset:16896
    v_pk_add_f32 v[80:81], v[80:81], v[24:25] neg_lo:[0,1] neg_hi:[0,1]
    v_pk_add_f32 v[82:83], v[82:83], v[24:25] neg_lo:[0,1] neg_hi:[0,1]
    v_pk_add_f32 v[84:85], v[84:85], v[24:25] neg_lo:[0,1] neg_hi:[0,1]
    v_pk_add_f32 v[86:87], v[86:87], v[24:25] neg_lo:[0,1] neg_hi:[0,1]
    v_exp_f32 v80, v80
    v_exp_f32 v81, v81
    v_exp_f32 v82, v82
    v_exp_f32 v83, v83
    v_exp_f32 v84, v84
    v_exp_f32 v85, v85
    v_exp_f32 v86, v86
    v_exp_f32 v87, v87
    s_add_u32 m0, s95, 24576
    s_add_u32 s92, s90, 229376
    buffer_load_dwordx4 v253, s[84:87], s90 offen lds
    s_cmp_eq_u32 s92, s91
    s_cselect_b32 s90, s94, s92
    v_cvt_pk_bf16_f32 v132, v80, v81
    v_cvt_pk_bf16_f32 v133, v82, v83
    v_cvt_pk_bf16_f32 v134, v84, v85
    v_cvt_pk_bf16_f32 v135, v86, v87
    v_pk_add_f32 v[26:27], v[26:27], v[80:81]
    v_pk_add_f32 v[26:27], v[26:27], v[82:83]
    v_pk_add_f32 v[26:27], v[26:27], v[84:85]
    v_pk_add_f32 v[26:27], v[26:27], v[86:87]
    s_waitcnt lgkmcnt(6)
    v_mfma_f32_16x16x32_bf16 v[124:127], v[100:103], v[132:135], v[124:127]
    v_mfma_f32_16x16x32_bf16 v[128:131], v[104:107], v[132:135], v[128:131]
    v_pk_add_f32 v[88:89], v[88:89], v[24:25] neg_lo:[0,1] neg_hi:[0,1]
    v_pk_add_f32 v[90:91], v[90:91], v[24:25] neg_lo:[0,1] neg_hi:[0,1]
    v_pk_add_f32 v[92:93], v[92:93], v[24:25] neg_lo:[0,1] neg_hi:[0,1]
    v_pk_add_f32 v[94:95], v[94:95], v[24:25] neg_lo:[0,1] neg_hi:[0,1]
    v_exp_f32 v88, v88
    v_exp_f32 v89, v89
    v_exp_f32 v90, v90
    v_exp_f32 v91, v91
    v_exp_f32 v92, v92
    v_exp_f32 v93, v93
    v_exp_f32 v94, v94
    v_exp_f32 v95, v95
    s_nop 0
    v_cvt_pk_bf16_f32 v136, v88, v89
    v_cvt_pk_bf16_f32 v137, v90, v91
    v_cvt_pk_bf16_f32 v138, v92, v93
    v_cvt_pk_bf16_f32 v139, v94, v95
    v_pk_add_f32 v[26:27], v[26:27], v[88:89]
    v_pk_add_f32 v[26:27], v[26:27], v[90:91]
    v_pk_add_f32 v[26:27], v[26:27], v[92:93]
    v_pk_add_f32 v[26:27], v[26:27], v[94:95]
    s_waitcnt lgkmcnt(2)
    v_mfma_f32_16x16x32_bf16 v[124:127], v[108:111], v[136:139], v[124:127]
    v_mfma_f32_16x16x32_bf16 v[128:131], v[112:115], v[136:139], v[128:131]
    v_pk_add_f32 v[96:97], v[96:97], v[24:25] neg_lo:[0,1] neg_hi:[0,1]
    v_pk_add_f32 v[98:99], v[98:99], v[24:25] neg_lo:[0,1] neg_hi:[0,1]
    v_exp_f32 v96, v96
    v_exp_f32 v97, v97
    v_exp_f32 v98, v98
    v_exp_f32 v99, v99
    s_nop 0
    v_cvt_pk_bf16_f32 v132, v96, v97
    v_cvt_pk_bf16_f32 v133, v98, v99
    v_pk_add_f32 v[26:27], v[26:27], v[96:97]
    v_pk_add_f32 v[26:27], v[26:27], v[98:99]
    s_waitcnt lgkmcnt(0)
    v_mfma_f32_16x16x16_bf16 v[124:127], v[116:117], v[132:133], v[124:127]
    v_mfma_f32_16x16x16_bf16 v[128:131], v[120:121], v[132:133], v[128:131]
    v_add_f32 v26, v26, v27
    v_mov_b32 v27, v26
    s_nop 1
    v_permlane32_swap_b32 v26, v27
    v_add_f32 v26, v26, v27
    v_mov_b32 v27, v26
    s_nop 1
    v_permlane16_swap_b32 v26, v27
    v_add_f32 v26, v26, v27
    v_rcp_f32 v26, v26
    s_nop 0
    v_mul_f32 v124, v26, v124
    v_mul_f32 v125, v26, v125
    v_mul_f32 v126, v26, v126
    v_mul_f32 v127, v26, v127
    v_mul_f32 v128, v26, v128
    v_mul_f32 v129, v26, v129
    v_mul_f32 v130, v26, v130
    v_mul_f32 v131, v26, v131
    v_cvt_pk_bf16_f32 v132, v124, v125
    v_cvt_pk_bf16_f32 v133, v126, v127
    v_cvt_pk_bf16_f32 v134, v128, v129
    v_cvt_pk_bf16_f32 v135, v130, v131
    s_waitcnt vmcnt(2)
    v_cmp_eq_u32 vcc, 0, v31
    s_nop 3
    s_cmp_eq_u32 vcc_lo, 0
    s_cbranch_scc1 L_kb_idok
    s_mov_b32 exec_lo, -1
    s_mov_b32 exec_hi, 0
    s_mov_b32 s101, 0
L_kb_wid_pl:
    buffer_load_dword v31, v250, s[28:31], s74 offen sc1
    s_add_u32 s101, s101, 1
    s_waitcnt vmcnt(0)
    v_cmp_eq_u32 vcc, 0, v31
    s_cmp_gt_u32 s101, 200000
    s_cbranch_scc1 L_kb_wid_pd
    s_nop 3
    s_cbranch_vccz L_kb_wid_pd
    s_sleep 1
    s_branch L_kb_wid_pl
L_kb_wid_pd:
    s_mov_b64 exec, -1
L_kb_idok:
    v_cmp_ne_u32 vcc, s3, v31
    s_nop 3
    s_cmp_eq_u32 vcc_lo, 0
    s_cselect_b32 s27, 1, 0
    s_cmp_eq_u32 s27, 0
    s_cbranch_scc1 L_hs1a
    buffer_store_dwordx2 v[132:133], v28, s[48:51], s46 offen
    buffer_store_dwordx2 v[134:135], v29, s[48:51], s46 offen
    s_branch L_hs1b
L_hs1a:
    buffer_store_dwordx2 v[132:133], v28, s[48:51], s46 offen sc1
    buffer_store_dwordx2 v[134:135], v29, s[48:51], s46 offen sc1
L_hs1b:
    s_waitcnt vmcnt(0)
    s_barrier
    s_cmp_lg_u32 s24, 1
    s_cbranch_scc1 L_kb_s2_nosig
    v_mov_b32 v2, 1
    v_mov_b32 v3, 0
    s_mov_b64 exec, 1
    s_cmp_eq_u32 s27, 0
    s_cbranch_scc1 L_hs2a
    buffer_store_dword v2, v3, s[28:31], s33 offen
    s_branch L_hs2b
L_hs2a:
    buffer_store_dword v2, v3, s[28:31], s33 offen sc1
L_hs2b:
    s_mov_b64 exec, -1
L_kb_s2_nosig:
    s_cmp_lg_u32 s24, 2
    s_cbranch_scc1 L_kb_nofn
    s_lshl_b32 s33, s26, 2
    s_add_u32 s33, s33, s74
    s_add_u32 s33, s33, 4096
    v_mov_b32 v2, 1
    v_mov_b32 v3, 0
    s_mov_b64 exec, 1
    buffer_store_dword v2, v3, s[28:31], s33 offen sc1
    s_mov_b64 exec, -1
L_kb_nofn:
    s_cmp_ge_u32 s26, 28
    s_cbranch_scc1 L_kb_spare2
    s_and_b32 s36, s24, 3
    s_lshr_b32 s37, s24, 2
    s_lshr_b32 s38, s36, 1
    s_and_b32 s39, s36, 1
    v_lshrrev_b32 v4, 5, v1
    v_bfe_u32 v5, v1, 2, 2
    v_lshl_add_u32 v8, v4, 3, v5
    v_lshlrev_b32 v8, 7, v8
    v_lshrrev_b32 v5, 1, v5
    v_xor_b32 v5, s38, v5
    v_lshl_add_u32 v8, v5, 6, v8
    v_bfe_u32 v5, v1, 4, 1
    v_xor_b32 v5, s39, v5
    v_lshl_add_u32 v8, v5, 5, v8
    v_and_b32 v5, 1, v1
    v_lshl_add_u32 v8, v5, 4, v8
    v_bfe_u32 v5, v1, 1, 1
    v_lshl_add_u32 v8, v5, 3, v8
    s_lshl_b32 s40, s36, 11
    v_add_u32 v8, s40, v8
    v_xor_b32 v9, 64, v8
    v_add_u32 v10, 0x10000, v8
    v_add_u32 v11, 0x10000, v9
    s_add_u32 s56, s22, 8388608
    s_addc_u32 s57, s23, 0
    s_and_b32 s57, s57, 0xffff
    s_mov_b32 s58, 1835008
    s_mov_b32 s59, 0x00020000
    s_add_u32 s60, s22, 18939904
    s_addc_u32 s61, s23, 0
    s_and_b32 s61, s61, 0xffff
    s_mov_b32 s62, 114688
    s_mov_b32 s63, 0x00020000
    s_lshl_b32 s40, s88, 1
    s_add_u32 s40, s40, s37
    s_mul_i32 s41, s40, 114688
    s_lshl_b32 s42, s36, 10
    s_add_u32 s41, s41, s42
    s_add_u32 s43, s41, 28672
    s_lshl_b32 s42, s77, 12
    s_add_u32 s42, s42, s41
    s_mul_i32 s45, s40, 28672
    s_lshl_b32 s46, s89, 12
    s_add_u32 s45, s45, s46
    s_lshl_b32 s46, s36, 10
    s_add_u32 s45, s45, s46
    s_mul_i32 s46, s37, 24576
    s_add_u32 s46, s46, 114688
    s_mul_i32 s47, s36, 6144
    s_add_u32 s47, s47, s46
    v_add_u32 v24, s47, v251
    s_xor_b32 s47, s36, 1
    s_mul_i32 s47, s47, 6144
    s_add_u32 s47, s47, s46
    v_add_u32 v25, s47, v251
    s_xor_b32 s47, s36, 2
    s_mul_i32 s47, s47, 6144
    s_add_u32 s47, s47, s46
    v_add_u32 v26, s47, v251
    s_xor_b32 s47, s36, 3
    s_mul_i32 s47, s47, 6144
    s_add_u32 s47, s47, s46
    v_add_u32 v27, s47, v251
    s_mul_i32 s44, s89, 16384
    s_lshl_b32 s47, s24, 9
    s_add_u32 s47, s47, 50176
    v_lshlrev_b32 v28, 3, v1
    v_add_u32 v28, s47, v28
    s_lshl_b32 s47, s37, 11
    s_add_u32 s47, s47, 50176
    v_and_b32 v29, 31, v1
    v_lshlrev_b32 v29, 3, v29
    v_add_u32 v29, s47, v29
    s_lshl_b32 s47, s40, 8
    s_add_u32 s44, s44, s47
    v_lshlrev_b32 v14, 3, v1
    v_mov_b32 v15, 0x40000000
    v_cmp_gt_u32 vcc, 32, v1
    s_nop 1
    v_cndmask_b32 v14, v15, v14, vcc
    s_lshl_b32 s47, s26, 2
    s_add_u32 s34, s74, s47
    s_add_u32 s34, s34, 2048
    s_lshr_b32 s46, s88, 1
    s_lshl_b32 s46, s46, 6
    s_add_u32 s46, s46, 1024
    s_mov_b32 s47, 0xffff0000
    s_cmp_lg_u32 s24, 0
    s_cbranch_scc1 L_kb_w2_pw
    s_mov_b32 exec_lo, 65535
    s_mov_b32 exec_hi, 0
    s_mov_b32 s101, 0
L_kb_w2_pl:
    buffer_load_dword v2, v250, s[28:31], s46 offen sc1
    s_add_u32 s101, s101, 1
    s_waitcnt vmcnt(0)
    v_cmp_eq_u32 vcc, 0, v2
    s_cmp_gt_u32 s101, 200000
    s_cbranch_scc1 L_kb_w2_pd
    s_nop 3
    s_cbranch_vccz L_kb_w2_pd
    s_sleep 1
    s_branch L_kb_w2_pl
L_kb_w2_pd:
    s_mov_b64 exec, -1
L_kb_w2_pw:
    s_barrier
    s_add_u32 s46, s42, 4096
    buffer_load_dwordx4 v[96:99], v251, s[48:51], s42 offen sc1
    s_cmp_eq_u32 s46, s43
    s_cselect_b32 s42, s41, s46
    s_add_u32 s46, s42, 4096
    buffer_load_dwordx4 v[100:103], v251, s[48:51], s42 offen sc1
    s_cmp_eq_u32 s46, s43
    s_cselect_b32 s42, s41, s46
    s_add_u32 s46, s42, 4096
    buffer_load_dwordx4 v[104:107], v251, s[48:51], s42 offen sc1
    s_cmp_eq_u32 s46, s43
    s_cselect_b32 s42, s41, s46
    s_add_u32 s46, s42, 4096
    buffer_load_dwordx4 v[108:111], v251, s[48:51], s42 offen sc1
    s_cmp_eq_u32 s46, s43
    s_cselect_b32 s42, s41, s46
    s_add_u32 s46, s42, 4096
    buffer_load_dwordx4 v[112:115], v251, s[48:51], s42 offen sc1
    s_cmp_eq_u32 s46, s43
    s_cselect_b32 s42, s41, s46
    s_add_u32 s46, s42, 4096
    buffer_load_dwordx4 v[116:119], v251, s[48:51], s42 offen sc1
    s_cmp_eq_u32 s46, s43
    s_cselect_b32 s42, s41, s46
    s_add_u32 s46, s42, 4096
    buffer_load_dwordx4 v[120:123], v251, s[48:51], s42 offen sc1
    s_cmp_eq_u32 s46, s43
    s_cselect_b32 s42, s41, s46
    s_add_u32 m0, s95, 32768
    s_nop 0
    buffer_load_dwordx4 v252, s[80:83], s90 offen lds
    s_add_u32 m0, s95, 40960
    s_add_u32 s92, s90, 229376
    buffer_load_dwordx4 v253, s[84:87], s90 offen lds
    s_cmp_eq_u32 s92, s91
    s_cselect_b32 s90, s94, s92
    ds_read_b64_tr_b16 v[64:65], v8 offset:57344
    ds_read_b64_tr_b16 v[66:67], v8 offset:57856
    ds_read_b64_tr_b16 v[68:69], v9 offset:57344
    ds_read_b64_tr_b16 v[70:71], v9 offset:57856
    ds_read_b64_tr_b16 v[72:73], v10 offset:0
    ds_read_b64_tr_b16 v[74:75], v10 offset:512
    ds_read_b64_tr_b16 v[76:77], v11 offset:0
    ds_read_b64_tr_b16 v[78:79], v11 offset:512
    s_waitcnt vmcnt(8)
    s_waitcnt lgkmcnt(4)
    v_mfma_f32_32x32x16_bf16 v[32:47], v[64:67], v[96:99], 0
    v_mfma_f32_32x32x16_bf16 v[48:63], v[68:71], v[96:99], 0
    ds_read_b64_tr_b16 v[64:65], v10 offset:8192
    ds_read_b64_tr_b16 v[66:67], v10 offset:8704
    ds_read_b64_tr_b16 v[68:69], v11 offset:8192
    ds_read_b64_tr_b16 v[70:71], v11 offset:8704
    s_waitcnt vmcnt(7)
    s_waitcnt lgkmcnt(4)
    v_mfma_f32_32x32x16_bf16 v[32:47], v[72:75], v[100:103], v[32:47]
    v_mfma_f32_32x32x16_bf16 v[48:63], v[76:79], v[100:103], v[48:63]
    ds_read_b64_tr_b16 v[72:73], v10 offset:16384
    ds_read_b64_tr_b16 v[74:75], v10 offset:16896
    ds_read_b64_tr_b16 v[76:77], v11 offset:16384
    ds_read_b64_tr_b16 v[78:79], v11 offset:16896
    s_waitcnt vmcnt(6)
    s_waitcnt lgkmcnt(4)
    v_mfma_f32_32x32x16_bf16 v[32:47], v[64:67], v[104:107], v[32:47]
    v_mfma_f32_32x32x16_bf16 v[48:63], v[68:71], v[104:107], v[48:63]
    ds_read_b64_tr_b16 v[64:65], v10 offset:24576
    ds_read_b64_tr_b16 v[66:67], v10 offset:25088
    ds_read_b64_tr_b16 v[68:69], v11 offset:24576
    ds_read_b64_tr_b16 v[70:71], v11 offset:25088
    s_waitcnt vmcnt(5)
    s_waitcnt lgkmcnt(4)
    v_mfma_f32_32x32x16_bf16 v[32:47], v[72:75], v[108:111], v[32:47]
    v_mfma_f32_32x32x16_bf16 v[48:63], v[76:79], v[108:111], v[48:63]
    ds_read_b64_tr_b16 v[72:73], v10 offset:32768
    ds_read_b64_tr_b16 v[74:75], v10 offset:33280
    ds_read_b64_tr_b16 v[76:77], v11 offset:32768
    ds_read_b64_tr_b16 v[78:79], v11 offset:33280
    s_waitcnt vmcnt(4)
    s_waitcnt lgkmcnt(4)
    v_mfma_f32_32x32x16_bf16 v[32:47], v[64:67], v[112:115], v[32:47]
    v_mfma_f32_32x32x16_bf16 v[48:63], v[68:71], v[112:115], v[48:63]
    ds_read_b64_tr_b16 v[64:65], v10 offset:40960
    ds_read_b64_tr_b16 v[66:67], v10 offset:41472
    ds_read_b64_tr_b16 v[68:69], v11 offset:40960
    ds_read_b64_tr_b16 v[70:71], v11 offset:41472
    s_waitcnt vmcnt(3)
    s_waitcnt lgkmcnt(4)
    v_mfma_f32_32x32x16_bf16 v[32:47], v[72:75], v[116:119], v[32:47]
    v_mfma_f32_32x32x16_bf16 v[48:63], v[76:79], v[116:119], v[48:63]
    s_waitcnt vmcnt(2)
    s_waitcnt lgkmcnt(0)
    v_mfma_f32_32x32x16_bf16 v[32:47], v[64:67], v[120:123], v[32:47]
    v_mfma_f32_32x32x16_bf16 v[48:63], v[68:71], v[120:123], v[48:63]
    s_nop 7
    s_nop 3
    ds_write_b128 v24, v[40:43] offset:0
    ds_write_b128 v24, v[44:47] offset:1024
    ds_write_b128 v24, v[48:51] offset:2048
    ds_write_b128 v24, v[52:55] offset:3072
    ds_write_b128 v24, v[56:59] offset:4096
    ds_write_b128 v24, v[60:63] offset:5120
    v_lshlrev_b32 v64, 16, v240
    v_and_b32 v65, s47, v240
    v_lshlrev_b32 v66, 16, v241
    v_and_b32 v67, s47, v241
    v_lshlrev_b32 v68, 16, v242
    v_and_b32 v69, s47, v242
    v_lshlrev_b32 v70, 16, v243
    v_and_b32 v71, s47, v243
    v_pk_add_f32 v[32:33], v[32:33], v[64:65]
    v_pk_add_f32 v[34:35], v[34:35], v[66:67]
    v_pk_add_f32 v[36:37], v[36:37], v[68:69]
    v_pk_add_f32 v[38:39], v[38:39], v[70:71]
    s_waitcnt lgkmcnt(0)
    s_barrier
    ds_read_b128 v[104:107], v25 offset:0
    ds_read_b128 v[108:111], v25 offset:1024
    ds_read_b128 v[112:115], v26 offset:2048
    ds_read_b128 v[116:119], v26 offset:3072
    ds_read_b128 v[120:123], v27 offset:4096
    ds_read_b128 v[124:127], v27 offset:5120
    s_waitcnt lgkmcnt(4)
    v_pk_add_f32 v[32:33], v[32:33], v[104:105]
    v_pk_add_f32 v[34:35], v[34:35], v[106:107]
    v_pk_add_f32 v[36:37], v[36:37], v[108:109]
    v_pk_add_f32 v[38:39], v[38:39], v[110:111]
    s_waitcnt lgkmcnt(2)
    v_pk_add_f32 v[32:33], v[32:33], v[112:113]
    v_pk_add_f32 v[34:35], v[34:35], v[114:115]
    v_pk_add_f32 v[36:37], v[36:37], v[116:117]
    v_pk_add_f32 v[38:39], v[38:39], v[118:119]
    s_waitcnt lgkmcnt(0)
    v_pk_add_f32 v[32:33], v[32:33], v[120:121]
    v_pk_add_f32 v[34:35], v[34:35], v[122:123]
    v_pk_add_f32 v[36:37], v[36:37], v[124:125]
    v_pk_add_f32 v[38:39], v[38:39], v[126:127]
    v_cvt_pk_bf16_f32 v16, v32, v33
    v_cvt_pk_bf16_f32 v17, v34, v35
    v_cvt_pk_bf16_f32 v18, v36, v37
    v_cvt_pk_bf16_f32 v19, v38, v39
    s_cmp_eq_u32 s27, 0
    s_cbranch_scc1 L_hs3a
    buffer_store_dwordx4 v[16:19], v251, s[56:59], s45 offen
    s_branch L_hs3b
L_hs3a:
    buffer_store_dwordx4 v[16:19], v251, s[56:59], s45 offen sc1
L_hs3b:
    v_mov_b32 v22, 0x3f803f80
    v_mov_b32 v20, 0
    v_mov_b32 v21, 0
    v_dot2c_f32_bf16 v20, v16, v22
    v_dot2c_f32_bf16 v21, v16, v16
    v_dot2c_f32_bf16 v20, v17, v22
    v_dot2c_f32_bf16 v21, v17, v17
    v_dot2c_f32_bf16 v20, v18, v22
    v_dot2c_f32_bf16 v21, v18, v18
    v_dot2c_f32_bf16 v20, v19, v22
    v_dot2c_f32_bf16 v21, v19, v19
    s_nop 2
    ds_write_b64 v28, v[20:21]
    s_waitcnt lgkmcnt(0)
    s_barrier
    s_cmp_lg_u32 s36, 0
    s_cbranch_scc1 L_kb_p3_nost
    ds_read_b64 v[32:33], v29 offset:0
    ds_read_b64 v[34:35], v29 offset:256
    ds_read_b64 v[36:37], v29 offset:512
    ds_read_b64 v[38:39], v29 offset:768
    ds_read_b64 v[40:41], v29 offset:1024
    ds_read_b64 v[42:43], v29 offset:1280
    ds_read_b64 v[44:45], v29 offset:1536
    ds_read_b64 v[46:47], v29 offset:1792
    s_waitcnt lgkmcnt(0)
    v_pk_add_f32 v[32:33], v[32:33], v[34:35]
    v_pk_add_f32 v[36:37], v[36:37], v[38:39]
    v_pk_add_f32 v[40:41], v[40:41], v[42:43]
    v_pk_add_f32 v[44:45], v[44:45], v[46:47]
    v_pk_add_f32 v[32:33], v[32:33], v[36:37]
    v_pk_add_f32 v[40:41], v[40:41], v[44:45]
    v_pk_add_f32 v[32:33], v[32:33], v[40:41]
    s_cmp_eq_u32 s27, 0
    s_cbranch_scc1 L_hs4a
    buffer_store_dwordx2 v[32:33], v14, s[60:63], s44 offen
    s_branch L_hs4b
L_hs4a:
    buffer_store_dwordx2 v[32:33], v14, s[60:63], s44 offen sc1
L_hs4b:
L_kb_p3_nost:
    s_waitcnt vmcnt(0)
    s_barrier
    s_cmp_lg_u32 s24, 1
    s_cbranch_scc1 L_kb_s3_nosig
    v_mov_b32 v2, 1
    v_mov_b32 v3, 0
    s_mov_b64 exec, 1
    s_cmp_eq_u32 s27, 0
    s_cbranch_scc1 L_hs5a
    buffer_store_dword v2, v3, s[28:31], s34 offen
    s_branch L_hs5b
L_hs5a:
    buffer_store_dword v2, v3, s[28:31], s34 offen sc1
L_hs5b:
    s_mov_b64 exec, -1
L_kb_s3_nosig:
    s_mov_b32 s96, s16
    s_mov_b32 s97, s17
    s_and_b32 s97, s97, 0xffff
    s_mov_b32 s98, 1605632
    s_mov_b32 s99, 0x00020000
    s_mul_i32 s79, s93, 57344
    s_add_u32 s79, s79, s78
    s_add_u32 s75, s78, 1605632
    v_lshrrev_b32 v4, 5, v1
    v_bfe_u32 v5, v1, 2, 2
    v_lshl_add_u32 v9, v4, 3, v5
    v_lshlrev_b32 v9, 7, v9
    v_bfe_u32 v10, v1, 4, 1
    v_and_b32 v11, 1, v1
    v_lshl_add_u32 v9, v11, 4, v9
    v_bfe_u32 v11, v1, 1, 1
    v_lshl_add_u32 v9, v11, 3, v9
    v_lshrrev_b32 v5, 1, v5
    v_lshl_add_u32 v5, v10, 1, v5
    v_lshl_add_u32 v9, v5, 5, v9
    v_lshl_add_u32 v12, v10, 13, v9
    v_xor_b32 v13, 32, v12
    v_xor_b32 v14, 64, v12
    v_xor_b32 v15, 96, v12
    v_add_u32 v25, 114688, v12
    v_xor_b32 v26, 32, v25
    v_xor_b32 v27, 64, v25
    v_xor_b32 v29, 96, v25
    v_and_b32 v17, 31, v1
    v_lshlrev_b32 v17, 3, v17
    v_mul_u32_u24 v16, 16384, v4
    v_add_u32 v17, v17, v16
    v_lshlrev_b32 v28, 5, v4
    s_lshl_b32 s56, s25, 3
    s_add_u32 s56, s56, s24
    s_mul_i32 s57, s56, 28672
    s_add_u32 s54, s57, 28672
    s_mul_i32 s55, s89, 4096
    s_add_u32 s55, s55, s57
    s_lshl_b32 s58, s56, 8
    s_mul_i32 s59, s56, 114688
    s_lshl_b32 s60, s26, 12
    s_add_u32 s59, s59, s60
    s_lshl_b32 s60, s26, 8
    s_add_u32 s61, s60, 7168
    s_add_u32 s36, s22, 8388608
    s_addc_u32 s37, s23, 0
    s_and_b32 s37, s37, 0xffff
    s_mov_b32 s38, 1835008
    s_mov_b32 s39, 0x00020000
    s_add_u32 s40, s22, 10485760
    s_addc_u32 s41, s23, 0
    s_and_b32 s41, s41, 0xffff
    s_mov_b32 s42, 7340032
    s_mov_b32 s43, 0x00020000
    s_add_u32 s44, s22, 18939904
    s_addc_u32 s45, s23, 0
    s_and_b32 s45, s45, 0xffff
    s_mov_b32 s46, 114688
    s_mov_b32 s47, 0x00020000
    s_add_u32 s48, s22, 18874368
    s_addc_u32 s49, s23, 0
    s_and_b32 s49, s49, 0xffff
    s_mov_b32 s50, 14336
    s_mov_b32 s51, 0x00020000
    s_lshl_b32 s35, s26, 2
    s_add_u32 s35, s35, s74
    s_add_u32 s35, s35, 3072
    s_add_u32 s62, s74, 2048
    v_mul_u32_u24 v16, 2048, v4
    v_add_u32 v16, v16, v250
    s_cmp_eq_u32 s25, 7
    s_cselect_b32 s63, 0, -1
    s_add_u32 m0, s95, 114688
    s_nop 0
    buffer_load_dwordx4 v252, s[80:83], s90 offen lds
    s_add_u32 m0, s95, 122880
    s_add_u32 s92, s90, 229376
    buffer_load_dwordx4 v253, s[84:87], s90 offen lds
    s_cmp_eq_u32 s92, s91
    s_cselect_b32 s90, s94, s92
    s_cmp_lg_u32 s24, 0
    s_cbranch_scc1 L_kb_w3_pw
    s_mov_b32 exec_lo, 268435455
    s_mov_b32 exec_hi, s63
    s_mov_b32 s101, 0
L_kb_w3_pl:
    buffer_load_dword v2, v16, s[28:31], s62 offen sc1
    s_add_u32 s101, s101, 1
    s_waitcnt vmcnt(0)
    v_cmp_eq_u32 vcc, 0, v2
    s_cmp_gt_u32 s101, 200000
    s_cbranch_scc1 L_kb_w3_pd
    s_nop 3
    s_cbranch_vccz L_kb_w3_pd
    s_sleep 1
    s_branch L_kb_w3_pl
L_kb_w3_pd:
    s_mov_b64 exec, -1
L_kb_w3_pw:
    s_barrier
    buffer_load_dwordx4 v[64:67], v251, s[36:39], s55 offen offset:0
    buffer_load_dwordx4 v[68:71], v251, s[36:39], s55 offen offset:1024
    buffer_load_dwordx4 v[72:75], v251, s[36:39], s55 offen offset:2048
    buffer_load_dwordx4 v[76:79], v251, s[36:39], s55 offen offset:3072
    s_add_u32 s55, s55, 4096
    s_cmp_eq_u32 s55, s54
    s_cselect_b32 s55, s57, s55
    buffer_load_dwordx4 v[80:83], v251, s[36:39], s55 offen offset:0
    buffer_load_dwordx4 v[84:87], v251, s[36:39], s55 offen offset:1024
    ds_read_b64_tr_b16 v[32:33], v12 offset:0
    ds_read_b64_tr_b16 v[34:35], v12 offset:512
    ds_read_b64_tr_b16 v[36:37], v13 offset:0
    ds_read_b64_tr_b16 v[38:39], v13 offset:512
    ds_read_b64_tr_b16 v[40:41], v14 offset:0
    ds_read_b64_tr_b16 v[42:43], v14 offset:512
    ds_read_b64_tr_b16 v[44:45], v15 offset:0
    ds_read_b64_tr_b16 v[46:47], v15 offset:512
    ds_read_b64_tr_b16 v[48:49], v12 offset:2048
    ds_read_b64_tr_b16 v[50:51], v12 offset:2560
    ds_read_b64_tr_b16 v[52:53], v13 offset:2048
    ds_read_b64_tr_b16 v[54:55], v13 offset:2560
    s_waitcnt vmcnt(5)
    s_waitcnt lgkmcnt(10)
    v_mfma_f32_32x32x16_bf16 v[176:191], v[32:35], v[64:67], 0
    ds_read_b64_tr_b16 v[56:57], v14 offset:2048
    ds_read_b64_tr_b16 v[58:59], v14 offset:2560
    s_waitcnt lgkmcnt(10)
    v_mfma_f32_32x32x16_bf16 v[192:207], v[36:39], v[64:67], 0
    buffer_load_dwordx4 v[88:91], v251, s[36:39], s55 offen offset:2048
    ds_read_b64_tr_b16 v[60:61], v15 offset:2048
    ds_read_b64_tr_b16 v[62:63], v15 offset:2560
    s_waitcnt lgkmcnt(10)
    v_mfma_f32_32x32x16_bf16 v[208:223], v[40:43], v[64:67], 0
    s_add_u32 s62, s58, 0
    buffer_load_dwordx2 v[240:241], v17, s[44:47], s62 offen
    ds_read_b64_tr_b16 v[32:33], v12 offset:4096
    ds_read_b64_tr_b16 v[34:35], v12 offset:4608
    s_waitcnt lgkmcnt(10)
    v_mfma_f32_32x32x16_bf16 v[224:239], v[44:47], v[64:67], 0
    s_add_u32 m0, s95, 131072
    s_nop 0
    buffer_load_dwordx4 v252, s[80:83], s90 offen lds
    ds_read_b64_tr_b16 v[36:37], v13 offset:4096
    ds_read_b64_tr_b16 v[38:39], v13 offset:4608
    s_waitcnt vmcnt(7)
    s_waitcnt lgkmcnt(10)
    v_mfma_f32_32x32x16_bf16 v[176:191], v[48:51], v[68:71], v[176:191]
    buffer_load_dwordx4 v[92:95], v251, s[36:39], s55 offen offset:3072
    ds_read_b64_tr_b16 v[40:41], v14 offset:4096
    ds_read_b64_tr_b16 v[42:43], v14 offset:4608
    s_waitcnt lgkmcnt(10)
    v_mfma_f32_32x32x16_bf16 v[192:207], v[52:55], v[68:71], v[192:207]
    s_add_u32 s62, s58, 32768
    buffer_load_dwordx2 v[242:243], v17, s[44:47], s62 offen
    ds_read_b64_tr_b16 v[44:45], v15 offset:4096
    ds_read_b64_tr_b16 v[46:47], v15 offset:4608
    s_waitcnt lgkmcnt(10)
    v_mfma_f32_32x32x16_bf16 v[208:223], v[56:59], v[68:71], v[208:223]
    ds_read_b64_tr_b16 v[48:49], v12 offset:6144
    ds_read_b64_tr_b16 v[50:51], v12 offset:6656
    s_waitcnt lgkmcnt(10)
    v_mfma_f32_32x32x16_bf16 v[224:239], v[60:63], v[68:71], v[224:239]
    s_add_u32 s55, s55, 4096
    s_cmp_eq_u32 s55, s54
    s_cselect_b32 s55, s57, s55
    buffer_load_dwordx4 v[96:99], v251, s[36:39], s55 offen offset:0
    ds_read_b64_tr_b16 v[52:53], v13 offset:6144
    ds_read_b64_tr_b16 v[54:55], v13 offset:6656
    s_waitcnt vmcnt(9)
    s_waitcnt lgkmcnt(10)
    v_mfma_f32_32x32x16_bf16 v[176:191], v[32:35], v[72:75], v[176:191]
    s_add_u32 s62, s58, 65536
    buffer_load_dwordx2 v[244:245], v17, s[44:47], s62 offen
    ds_read_b64_tr_b16 v[56:57], v14 offset:6144
    ds_read_b64_tr_b16 v[58:59], v14 offset:6656
    s_waitcnt lgkmcnt(10)
    v_mfma_f32_32x32x16_bf16 v[192:207], v[36:39], v[72:75], v[192:207]
    s_add_u32 m0, s95, 139264
    s_add_u32 s92, s90, 229376
    buffer_load_dwordx4 v253, s[84:87], s90 offen lds
    s_cmp_eq_u32 s92, s91
    s_cselect_b32 s90, s94, s92
    ds_read_b64_tr_b16 v[60:61], v15 offset:6144
    ds_read_b64_tr_b16 v[62:63], v15 offset:6656
    s_waitcnt lgkmcnt(10)
    v_mfma_f32_32x32x16_bf16 v[208:223], v[40:43], v[72:75], v[208:223]
    buffer_load_dwordx4 v[100:103], v251, s[36:39], s55 offen offset:1024
    ds_read_b64_tr_b16 v[32:33], v12 offset:16384
    ds_read_b64_tr_b16 v[34:35], v12 offset:16896
    s_waitcnt lgkmcnt(10)
    v_mfma_f32_32x32x16_bf16 v[224:239], v[44:47], v[72:75], v[224:239]
    s_add_u32 s62, s58, 98304
    buffer_load_dwordx2 v[246:247], v17, s[44:47], s62 offen
    ds_read_b64_tr_b16 v[36:37], v13 offset:16384
    ds_read_b64_tr_b16 v[38:39], v13 offset:16896
    s_waitcnt vmcnt(12)
    s_waitcnt lgkmcnt(10)
    v_mfma_f32_32x32x16_bf16 v[176:191], v[48:51], v[76:79], v[176:191]
    ds_read_b64_tr_b16 v[40:41], v14 offset:16384
    ds_read_b64_tr_b16 v[42:43], v14 offset:16896
    s_waitcnt lgkmcnt(10)
    v_mfma_f32_32x32x16_bf16 v[192:207], v[52:55], v[76:79], v[192:207]
    buffer_load_dwordx4 v[104:107], v251, s[36:39], s55 offen offset:2048
    ds_read_b64_tr_b16 v[44:45], v15 offset:16384
    ds_read_b64_tr_b16 v[46:47], v15 offset:16896
    s_waitcnt lgkmcnt(10)
    v_mfma_f32_32x32x16_bf16 v[208:223], v[56:59], v[76:79], v[208:223]
    ds_read_b64_tr_b16 v[48:49], v12 offset:18432
    ds_read_b64_tr_b16 v[50:51], v12 offset:18944
    s_waitcnt lgkmcnt(10)
    v_mfma_f32_32x32x16_bf16 v[224:239], v[60:63], v[76:79], v[224:239]
    s_add_u32 m0, s95, 147456
    s_nop 0
    buffer_load_dwordx4 v252, s[80:83], s90 offen lds
    ds_read_b64_tr_b16 v[52:53], v13 offset:18432
    ds_read_b64_tr_b16 v[54:55], v13 offset:18944
    s_waitcnt vmcnt(13)
    s_waitcnt lgkmcnt(10)
    v_mfma_f32_32x32x16_bf16 v[176:191], v[32:35], v[80:83], v[176:191]
    buffer_load_dwordx4 v[108:111], v251, s[36:39], s55 offen offset:3072
    ds_read_b64_tr_b16 v[56:57], v14 offset:18432
    ds_read_b64_tr_b16 v[58:59], v14 offset:18944
    s_waitcnt lgkmcnt(10)
    v_mfma_f32_32x32x16_bf16 v[192:207], v[36:39], v[80:83], v[192:207]
    ds_read_b64_tr_b16 v[60:61], v15 offset:18432
    ds_read_b64_tr_b16 v[62:63], v15 offset:18944
    s_waitcnt lgkmcnt(10)
    v_mfma_f32_32x32x16_bf16 v[208:223], v[40:43], v[80:83], v[208:223]
    ds_read_b64_tr_b16 v[32:33], v12 offset:20480
    ds_read_b64_tr_b16 v[34:35], v12 offset:20992
    s_waitcnt lgkmcnt(10)
    v_mfma_f32_32x32x16_bf16 v[224:239], v[44:47], v[80:83], v[224:239]
    s_add_u32 s55, s55, 4096
    s_cmp_eq_u32 s55, s54
    s_cselect_b32 s55, s57, s55
    buffer_load_dwordx4 v[112:115], v251, s[36:39], s55 offen offset:0
    ds_read_b64_tr_b16 v[36:37], v13 offset:20480
    ds_read_b64_tr_b16 v[38:39], v13 offset:20992
    s_waitcnt vmcnt(14)
    s_waitcnt lgkmcnt(10)
    v_mfma_f32_32x32x16_bf16 v[176:191], v[48:51], v[84:87], v[176:191]
    ds_read_b64_tr_b16 v[40:41], v14 offset:20480
    ds_read_b64_tr_b16 v[42:43], v14 offset:20992
    s_waitcnt lgkmcnt(10)
    v_mfma_f32_32x32x16_bf16 v[192:207], v[52:55], v[84:87], v[192:207]
    s_add_u32 m0, s95, 155648
    s_add_u32 s92, s90, 229376
    buffer_load_dwordx4 v253, s[84:87], s90 offen lds
    s_cmp_eq_u32 s92, s91
    s_cselect_b32 s90, s94, s92
    ds_read_b64_tr_b16 v[44:45], v15 offset:20480
    ds_read_b64_tr_b16 v[46:47], v15 offset:20992
    s_waitcnt lgkmcnt(10)
    v_mfma_f32_32x32x16_bf16 v[208:223], v[56:59], v[84:87], v[208:223]
    buffer_load_dwordx4 v[116:119], v251, s[36:39], s55 offen offset:1024
    ds_read_b64_tr_b16 v[48:49], v12 offset:22528
    ds_read_b64_tr_b16 v[50:51], v12 offset:23040
    s_waitcnt lgkmcnt(10)
    v_mfma_f32_32x32x16_bf16 v[224:239], v[60:63], v[84:87], v[224:239]
    ds_read_b64_tr_b16 v[52:53], v13 offset:22528
    ds_read_b64_tr_b16 v[54:55], v13 offset:23040
    s_waitcnt vmcnt(15)
    s_waitcnt lgkmcnt(10)
    v_mfma_f32_32x32x16_bf16 v[176:191], v[32:35], v[88:91], v[176:191]
    ds_read_b64_tr_b16 v[56:57], v14 offset:22528
    ds_read_b64_tr_b16 v[58:59], v14 offset:23040
    s_waitcnt lgkmcnt(10)
    v_mfma_f32_32x32x16_bf16 v[192:207], v[36:39], v[88:91], v[192:207]
    buffer_load_dwordx4 v[120:123], v251, s[36:39], s55 offen offset:2048
    ds_read_b64_tr_b16 v[60:61], v15 offset:22528
    ds_read_b64_tr_b16 v[62:63], v15 offset:23040
    s_waitcnt lgkmcnt(10)
    v_mfma_f32_32x32x16_bf16 v[208:223], v[40:43], v[88:91], v[208:223]
    ds_read_b64_tr_b16 v[32:33], v12 offset:32768
    ds_read_b64_tr_b16 v[34:35], v12 offset:33280
    s_waitcnt lgkmcnt(10)
    v_mfma_f32_32x32x16_bf16 v[224:239], v[44:47], v[88:91], v[224:239]
    s_add_u32 m0, s95, 57344
    s_nop 0
    buffer_load_dwordx4 v252, s[80:83], s90 offen lds
    ds_read_b64_tr_b16 v[36:37], v13 offset:32768
    ds_read_b64_tr_b16 v[38:39], v13 offset:33280
    s_waitcnt vmcnt(14)
    s_waitcnt lgkmcnt(10)
    v_mfma_f32_32x32x16_bf16 v[176:191], v[48:51], v[92:95], v[176:191]
    buffer_load_dwordx4 v[124:127], v251, s[36:39], s55 offen offset:3072
    ds_read_b64_tr_b16 v[40:41], v14 offset:32768
    ds_read_b64_tr_b16 v[42:43], v14 offset:33280
    s_waitcnt lgkmcnt(10)
    v_mfma_f32_32x32x16_bf16 v[192:207], v[52:55], v[92:95], v[192:207]
    ds_read_b64_tr_b16 v[44:45], v15 offset:32768
    ds_read_b64_tr_b16 v[46:47], v15 offset:33280
    s_waitcnt lgkmcnt(10)
    v_mfma_f32_32x32x16_bf16 v[208:223], v[56:59], v[92:95], v[208:223]
    ds_read_b64_tr_b16 v[48:49], v12 offset:34816
    ds_read_b64_tr_b16 v[50:51], v12 offset:35328
    s_waitcnt lgkmcnt(10)
    v_mfma_f32_32x32x16_bf16 v[224:239], v[60:63], v[92:95], v[224:239]
    s_add_u32 s55, s55, 4096
    s_cmp_eq_u32 s55, s54
    s_cselect_b32 s55, s57, s55
    buffer_load_dwordx4 v[128:131], v251, s[36:39], s55 offen offset:0
    ds_read_b64_tr_b16 v[52:53], v13 offset:34816
    ds_read_b64_tr_b16 v[54:55], v13 offset:35328
    s_waitcnt vmcnt(14)
    s_waitcnt lgkmcnt(10)
    v_mfma_f32_32x32x16_bf16 v[176:191], v[32:35], v[96:99], v[176:191]
    ds_read_b64_tr_b16 v[56:57], v14 offset:34816
    ds_read_b64_tr_b16 v[58:59], v14 offset:35328
    s_waitcnt lgkmcnt(10)
    v_mfma_f32_32x32x16_bf16 v[192:207], v[36:39], v[96:99], v[192:207]
    s_add_u32 m0, s95, 65536
    s_add_u32 s92, s90, 229376
    buffer_load_dwordx4 v253, s[84:87], s90 offen lds
    s_cmp_eq_u32 s92, s91
    s_cselect_b32 s90, s94, s92
    ds_read_b64_tr_b16 v[60:61], v15 offset:34816
    ds_read_b64_tr_b16 v[62:63], v15 offset:35328
    s_waitcnt lgkmcnt(10)
    v_mfma_f32_32x32x16_bf16 v[208:223], v[40:43], v[96:99], v[208:223]
    buffer_load_dwordx4 v[132:135], v251, s[36:39], s55 offen offset:1024
    ds_read_b64_tr_b16 v[32:33], v12 offset:36864
    ds_read_b64_tr_b16 v[34:35], v12 offset:37376
    s_waitcnt lgkmcnt(10)
    v_mfma_f32_32x32x16_bf16 v[224:239], v[44:47], v[96:99], v[224:239]
    ds_read_b64_tr_b16 v[36:37], v13 offset:36864
    ds_read_b64_tr_b16 v[38:39], v13 offset:37376
    s_waitcnt vmcnt(13)
    s_waitcnt lgkmcnt(10)
    v_mfma_f32_32x32x16_bf16 v[176:191], v[48:51], v[100:103], v[176:191]
    v_and_b32 v30, 31, v1
    v_lshlrev_b32 v30, 7, v30
    s_cmp_ge_u32 s26, 0
    s_cselect_b32 s62, s59, 0x40000000
    buffer_load_dword v31, v30, s[40:43], s62 offen sc1
    ds_read_b64_tr_b16 v[40:41], v14 offset:36864
    ds_read_b64_tr_b16 v[42:43], v14 offset:37376
    s_waitcnt lgkmcnt(10)
    v_mfma_f32_32x32x16_bf16 v[192:207], v[52:55], v[100:103], v[192:207]
    buffer_load_dwordx4 v[136:139], v251, s[36:39], s55 offen offset:2048
    ds_read_b64_tr_b16 v[44:45], v15 offset:36864
    ds_read_b64_tr_b16 v[46:47], v15 offset:37376
    s_waitcnt lgkmcnt(10)
    v_mfma_f32_32x32x16_bf16 v[208:223], v[56:59], v[100:103], v[208:223]
    ds_read_b64_tr_b16 v[48:49], v12 offset:38912
    ds_read_b64_tr_b16 v[50:51], v12 offset:39424
    s_waitcnt lgkmcnt(10)
    v_mfma_f32_32x32x16_bf16 v[224:239], v[60:63], v[100:103], v[224:239]
    ds_read_b64_tr_b16 v[52:53], v13 offset:38912
    ds_read_b64_tr_b16 v[54:55], v13 offset:39424
    s_waitcnt vmcnt(13)
    s_waitcnt lgkmcnt(10)
    v_mfma_f32_32x32x16_bf16 v[176:191], v[32:35], v[104:107], v[176:191]
    buffer_load_dwordx4 v[140:143], v251, s[36:39], s55 offen offset:3072
    v_add_f32 v240, v240, v242
    v_add_f32 v241, v241, v243
    v_add_f32 v240, v240, v244
    v_add_f32 v241, v241, v245
    v_add_f32 v240, v240, v246
    v_add_f32 v241, v241, v247
    v_mov_b32 v18, v240
    v_mov_b32 v19, v241
    s_nop 1
    v_permlane32_swap_b32 v18, v240
    v_permlane32_swap_b32 v19, v241
    v_add_f32 v18, v18, v240
    v_add_f32 v19, v19, v241
    v_mul_f32 v18, 991054117, v18
    v_mul_f32 v19, 991054117, v19
    v_fma_f32 v19, -v18, v18, v19
    v_max_f32 v19, 0, v19
    v_add_f32 v24, 925353388, v19
    v_rsq_f32 v20, v24
    v_sub_f32 v22, 0, v18
    v_mul_f32 v20, 3216550459, v20
    ds_read_b64_tr_b16 v[56:57], v14 offset:38912
    ds_read_b64_tr_b16 v[58:59], v14 offset:39424
    s_waitcnt lgkmcnt(10)
    v_mfma_f32_32x32x16_bf16 v[192:207], v[36:39], v[104:107], v[192:207]
    ds_read_b64_tr_b16 v[60:61], v15 offset:38912
    ds_read_b64_tr_b16 v[62:63], v15 offset:39424
    s_waitcnt lgkmcnt(10)
    v_mfma_f32_32x32x16_bf16 v[208:223], v[40:43], v[104:107], v[208:223]
    s_barrier
    ds_read_b64_tr_b16 v[32:33], v25 offset:0
    ds_read_b64_tr_b16 v[34:35], v25 offset:512
    s_waitcnt lgkmcnt(10)
    v_mfma_f32_32x32x16_bf16 v[224:239], v[44:47], v[104:107], v[224:239]
    s_add_u32 s55, s55, 4096
    s_cmp_eq_u32 s55, s54
    s_cselect_b32 s55, s57, s55
    buffer_load_dwordx4 v[144:147], v251, s[36:39], s55 offen offset:0
    ds_read_b64_tr_b16 v[36:37], v26 offset:0
    ds_read_b64_tr_b16 v[38:39], v26 offset:512
    s_waitcnt vmcnt(13)
    s_waitcnt lgkmcnt(10)
    v_mfma_f32_32x32x16_bf16 v[176:191], v[48:51], v[108:111], v[176:191]
    ds_read_b64_tr_b16 v[40:41], v27 offset:0
    ds_read_b64_tr_b16 v[42:43], v27 offset:512
    s_waitcnt lgkmcnt(10)
    v_mfma_f32_32x32x16_bf16 v[192:207], v[52:55], v[108:111], v[192:207]
    ds_read_b64_tr_b16 v[44:45], v29 offset:0
    ds_read_b64_tr_b16 v[46:47], v29 offset:512
    s_waitcnt lgkmcnt(10)
    v_mfma_f32_32x32x16_bf16 v[208:223], v[56:59], v[108:111], v[208:223]
    buffer_load_dwordx4 v[148:151], v251, s[36:39], s55 offen offset:1024
    ds_read_b64_tr_b16 v[48:49], v25 offset:2048
    ds_read_b64_tr_b16 v[50:51], v25 offset:2560
    s_waitcnt lgkmcnt(10)
    v_mfma_f32_32x32x16_bf16 v[224:239], v[60:63], v[108:111], v[224:239]
    ds_read_b64_tr_b16 v[52:53], v26 offset:2048
    ds_read_b64_tr_b16 v[54:55], v26 offset:2560
    s_waitcnt vmcnt(13)
    s_waitcnt lgkmcnt(10)
    v_mfma_f32_32x32x16_bf16 v[176:191], v[32:35], v[112:115], v[176:191]
    ds_read_b64_tr_b16 v[56:57], v27 offset:2048
    ds_read_b64_tr_b16 v[58:59], v27 offset:2560
    s_waitcnt lgkmcnt(10)
    v_mfma_f32_32x32x16_bf16 v[192:207], v[36:39], v[112:115], v[192:207]
    buffer_load_dwordx4 v[152:155], v251, s[36:39], s55 offen offset:2048
    ds_read_b64_tr_b16 v[60:61], v29 offset:2048
    ds_read_b64_tr_b16 v[62:63], v29 offset:2560
    s_waitcnt lgkmcnt(10)
    v_mfma_f32_32x32x16_bf16 v[208:223], v[40:43], v[112:115], v[208:223]
    ds_read_b64_tr_b16 v[32:33], v25 offset:4096
    ds_read_b64_tr_b16 v[34:35], v25 offset:4608
    s_waitcnt lgkmcnt(10)
    v_mfma_f32_32x32x16_bf16 v[224:239], v[44:47], v[112:115], v[224:239]
    ds_read_b64_tr_b16 v[36:37], v26 offset:4096
    ds_read_b64_tr_b16 v[38:39], v26 offset:4608
    s_waitcnt vmcnt(12)
    s_waitcnt lgkmcnt(10)
    v_mfma_f32_32x32x16_bf16 v[176:191], v[48:51], v[116:119], v[176:191]
    buffer_load_dwordx4 v[156:159], v251, s[36:39], s55 offen offset:3072
    ds_read_b64_tr_b16 v[40:41], v27 offset:4096
    ds_read_b64_tr_b16 v[42:43], v27 offset:4608
    s_waitcnt lgkmcnt(10)
    v_mfma_f32_32x32x16_bf16 v[192:207], v[52:55], v[116:119], v[192:207]
    ds_read_b64_tr_b16 v[44:45], v29 offset:4096
    ds_read_b64_tr_b16 v[46:47], v29 offset:4608
    s_waitcnt lgkmcnt(10)
    v_mfma_f32_32x32x16_bf16 v[208:223], v[56:59], v[116:119], v[208:223]
    ds_read_b64_tr_b16 v[48:49], v25 offset:6144
    ds_read_b64_tr_b16 v[50:51], v25 offset:6656
    s_waitcnt lgkmcnt(10)
    v_mfma_f32_32x32x16_bf16 v[224:239], v[60:63], v[116:119], v[224:239]
    s_add_u32 s55, s55, 4096
    s_cmp_eq_u32 s55, s54
    s_cselect_b32 s55, s57, s55
    buffer_load_dwordx4 v[160:163], v251, s[36:39], s55 offen offset:0
    ds_read_b64_tr_b16 v[52:53], v26 offset:6144
    ds_read_b64_tr_b16 v[54:55], v26 offset:6656
    s_waitcnt vmcnt(13)
    s_waitcnt lgkmcnt(10)
    v_mfma_f32_32x32x16_bf16 v[176:191], v[32:35], v[120:123], v[176:191]
    ds_read_b64_tr_b16 v[56:57], v27 offset:6144
    ds_read_b64_tr_b16 v[58:59], v27 offset:6656
    s_waitcnt lgkmcnt(10)
    v_mfma_f32_32x32x16_bf16 v[192:207], v[36:39], v[120:123], v[192:207]
    ds_read_b64_tr_b16 v[60:61], v29 offset:6144
    ds_read_b64_tr_b16 v[62:63], v29 offset:6656
    s_waitcnt lgkmcnt(10)
    v_mfma_f32_32x32x16_bf16 v[208:223], v[40:43], v[120:123], v[208:223]
    buffer_load_dwordx4 v[164:167], v251, s[36:39], s55 offen offset:1024
    s_barrier
    ds_read_b64_tr_b16 v[32:33], v25 offset:16384
    ds_read_b64_tr_b16 v[34:35], v25 offset:16896
    s_waitcnt lgkmcnt(10)
    v_mfma_f32_32x32x16_bf16 v[224:239], v[44:47], v[120:123], v[224:239]
    ds_read_b64_tr_b16 v[36:37], v26 offset:16384
    ds_read_b64_tr_b16 v[38:39], v26 offset:16896
    s_waitcnt vmcnt(12)
    s_waitcnt lgkmcnt(10)
    v_mfma_f32_32x32x16_bf16 v[176:191], v[48:51], v[124:127], v[176:191]
    ds_read_b64_tr_b16 v[40:41], v27 offset:16384
    ds_read_b64_tr_b16 v[42:43], v27 offset:16896
    s_waitcnt lgkmcnt(10)
    v_mfma_f32_32x32x16_bf16 v[192:207], v[52:55], v[124:127], v[192:207]
    buffer_load_dwordx4 v[168:171], v251, s[36:39], s55 offen offset:2048
    ds_read_b64_tr_b16 v[44:45], v29 offset:16384
    ds_read_b64_tr_b16 v[46:47], v29 offset:16896
    s_waitcnt lgkmcnt(10)
    v_mfma_f32_32x32x16_bf16 v[208:223], v[56:59], v[124:127], v[208:223]
    ds_read_b64_tr_b16 v[48:49], v25 offset:18432
    ds_read_b64_tr_b16 v[50:51], v25 offset:18944
    s_waitcnt lgkmcnt(10)
    v_mfma_f32_32x32x16_bf16 v[224:239], v[60:63], v[124:127], v[224:239]
    ds_read_b64_tr_b16 v[52:53], v26 offset:18432
    ds_read_b64_tr_b16 v[54:55], v26 offset:18944
    s_waitcnt vmcnt(12)
    s_waitcnt lgkmcnt(10)
    v_mfma_f32_32x32x16_bf16 v[176:191], v[32:35], v[128:131], v[176:191]
    buffer_load_dwordx4 v[172:175], v251, s[36:39], s55 offen offset:3072
    ds_read_b64_tr_b16 v[56:57], v27 offset:18432
    ds_read_b64_tr_b16 v[58:59], v27 offset:18944
    s_waitcnt lgkmcnt(10)
    v_mfma_f32_32x32x16_bf16 v[192:207], v[36:39], v[128:131], v[192:207]
    ds_read_b64_tr_b16 v[60:61], v29 offset:18432
    ds_read_b64_tr_b16 v[62:63], v29 offset:18944
    s_waitcnt lgkmcnt(10)
    v_mfma_f32_32x32x16_bf16 v[208:223], v[40:43], v[128:131], v[208:223]
    ds_read_b64_tr_b16 v[32:33], v25 offset:20480
    ds_read_b64_tr_b16 v[34:35], v25 offset:20992
    s_waitcnt lgkmcnt(10)
    v_mfma_f32_32x32x16_bf16 v[224:239], v[44:47], v[128:131], v[224:239]
    ds_read_b64_tr_b16 v[36:37], v26 offset:20480
    ds_read_b64_tr_b16 v[38:39], v26 offset:20992
    s_waitcnt vmcnt(11)
    s_waitcnt lgkmcnt(10)
    v_mfma_f32_32x32x16_bf16 v[176:191], v[48:51], v[132:135], v[176:191]
    ds_read_b64_tr_b16 v[40:41], v27 offset:20480
    ds_read_b64_tr_b16 v[42:43], v27 offset:20992
    s_waitcnt lgkmcnt(10)
    v_mfma_f32_32x32x16_bf16 v[192:207], v[52:55], v[132:135], v[192:207]
    ds_read_b64_tr_b16 v[44:45], v29 offset:20480
    ds_read_b64_tr_b16 v[46:47], v29 offset:20992
    s_waitcnt lgkmcnt(10)
    v_mfma_f32_32x32x16_bf16 v[208:223], v[56:59], v[132:135], v[208:223]
    ds_read_b128 v[64:67], v28 offset:49152
    ds_read_b128 v[68:71], v28 offset:49168
    ds_read_b128 v[72:75], v28 offset:49408
    ds_read_b128 v[76:79], v28 offset:49424
    ds_read_b64_tr_b16 v[48:49], v25 offset:22528
    ds_read_b64_tr_b16 v[50:51], v25 offset:23040
    s_waitcnt lgkmcnt(14)
    v_mfma_f32_32x32x16_bf16 v[224:239], v[60:63], v[132:135], v[224:239]
    ds_read_b64_tr_b16 v[52:53], v26 offset:22528
    ds_read_b64_tr_b16 v[54:55], v26 offset:23040
    s_waitcnt vmcnt(9)
    s_waitcnt lgkmcnt(14)
    v_mfma_f32_32x32x16_bf16 v[176:191], v[32:35], v[136:139], v[176:191]
    ds_read_b128 v[80:83], v28 offset:49216
    ds_read_b128 v[84:87], v28 offset:49232
    ds_read_b128 v[88:91], v28 offset:49472
    ds_read_b128 v[92:95], v28 offset:49488
    ds_read_b64_tr_b16 v[56:57], v27 offset:22528
    ds_read_b64_tr_b16 v[58:59], v27 offset:23040
    s_waitcnt lgkmcnt(15)
    v_mfma_f32_32x32x16_bf16 v[192:207], v[36:39], v[136:139], v[192:207]
    ds_read_b64_tr_b16 v[60:61], v29 offset:22528
    ds_read_b64_tr_b16 v[62:63], v29 offset:23040
    v_mfma_f32_32x32x16_bf16 v[208:223], v[40:43], v[136:139], v[208:223]
    ds_read_b128 v[96:99], v28 offset:49280
    ds_read_b128 v[100:103], v28 offset:49296
    ds_read_b128 v[104:107], v28 offset:49536
    ds_read_b128 v[108:111], v28 offset:49552
    s_barrier
    ds_read_b64_tr_b16 v[32:33], v25 offset:32768
    ds_read_b64_tr_b16 v[34:35], v25 offset:33280
    s_waitcnt lgkmcnt(15)
    v_mfma_f32_32x32x16_bf16 v[224:239], v[44:47], v[136:139], v[224:239]
    s_add_u32 m0, s95, 73728
    s_add_u32 s92, s79, 57344
    buffer_load_dwordx4 v254, s[96:99], s79 offen lds
    s_cmp_eq_u32 s92, s75
    s_cselect_b32 s79, s78, s92
    ds_read_b64_tr_b16 v[36:37], v25 offset:34816
    ds_read_b64_tr_b16 v[38:39], v25 offset:35328
    s_waitcnt vmcnt(9)
    v_mfma_f32_32x32x16_bf16 v[176:191], v[48:51], v[140:143], v[176:191]
    ds_read_b128 v[112:115], v28 offset:49344
    ds_read_b128 v[116:119], v28 offset:49360
    ds_read_b128 v[120:123], v28 offset:49600
    ds_read_b128 v[124:127], v28 offset:49616
    s_add_u32 m0, s95, 81920
    s_add_u32 s92, s79, 57344
    buffer_load_dwordx4 v254, s[96:99], s79 offen lds
    s_cmp_eq_u32 s92, s75
    s_cselect_b32 s79, s78, s92
    ds_read_b64_tr_b16 v[40:41], v25 offset:36864
    ds_read_b64_tr_b16 v[42:43], v25 offset:37376
    s_waitcnt lgkmcnt(15)
    v_mfma_f32_32x32x16_bf16 v[192:207], v[52:55], v[140:143], v[192:207]
    s_add_u32 m0, s95, 90112
    s_add_u32 s92, s79, 57344
    buffer_load_dwordx4 v254, s[96:99], s79 offen lds
    s_cmp_eq_u32 s92, s75
    s_cselect_b32 s79, s78, s92
    ds_read_b64_tr_b16 v[44:45], v25 offset:38912
    ds_read_b64_tr_b16 v[46:47], v25 offset:39424
    v_mfma_f32_32x32x16_bf16 v[208:223], v[56:59], v[140:143], v[208:223]
    s_add_u32 m0, s95, 98304
    s_add_u32 s92, s79, 57344
    buffer_load_dwordx4 v254, s[96:99], s79 offen lds
    s_cmp_eq_u32 s92, s75
    s_cselect_b32 s79, s78, s92
    ds_read_b64_tr_b16 v[48:49], v12 offset:57344
    ds_read_b64_tr_b16 v[50:51], v12 offset:57856
    s_waitcnt lgkmcnt(15)
    v_mfma_f32_32x32x16_bf16 v[224:239], v[60:63], v[140:143], v[224:239]
    s_add_u32 m0, s95, 106496
    s_add_u32 s92, s79, 57344
    buffer_load_dwordx4 v254, s[96:99], s79 offen lds
    s_cmp_eq_u32 s92, s75
    s_cselect_b32 s79, s78, s92
    ds_read_b64_tr_b16 v[52:53], v12 offset:59392
    ds_read_b64_tr_b16 v[54:55], v12 offset:59904
    s_waitcnt vmcnt(12)
    s_waitcnt lgkmcnt(14)
    v_mfma_f32_32x32x16_bf16 v[176:191], v[32:35], v[144:147], v[176:191]
    s_barrier
    ds_read_b64_tr_b16 v[56:57], v12 offset:61440
    ds_read_b64_tr_b16 v[58:59], v12 offset:61952
    s_waitcnt vmcnt(11)
    s_waitcnt lgkmcnt(14)
    v_mfma_f32_32x32x16_bf16 v[176:191], v[36:39], v[148:151], v[176:191]
    s_add_u32 m0, s95, 0
    s_add_u32 s92, s79, 57344
    buffer_load_dwordx4 v254, s[96:99], s79 offen lds
    s_cmp_eq_u32 s92, s75
    s_cselect_b32 s79, s78, s92
    ds_read_b64_tr_b16 v[60:61], v12 offset:63488
    ds_read_b64_tr_b16 v[62:63], v12 offset:64000
    s_waitcnt vmcnt(11)
    s_waitcnt lgkmcnt(10)
    v_mfma_f32_32x32x16_bf16 v[176:191], v[40:43], v[152:155], v[176:191]
    s_add_u32 m0, s95, 8192
    s_add_u32 s92, s79, 57344
    buffer_load_dwordx4 v254, s[96:99], s79 offen lds
    s_cmp_eq_u32 s92, s75
    s_cselect_b32 s79, s78, s92
    ds_read_b64_tr_b16 v[32:33], v26 offset:32768
    ds_read_b64_tr_b16 v[34:35], v26 offset:33280
    s_waitcnt vmcnt(11)
    s_waitcnt lgkmcnt(10)
    v_mfma_f32_32x32x16_bf16 v[176:191], v[44:47], v[156:159], v[176:191]
    s_add_u32 m0, s95, 16384
    s_add_u32 s92, s79, 57344
    buffer_load_dwordx4 v254, s[96:99], s79 offen lds
    s_cmp_eq_u32 s92, s75
    s_cselect_b32 s79, s78, s92
    ds_read_b64_tr_b16 v[36:37], v26 offset:34816
    ds_read_b64_tr_b16 v[38:39], v26 offset:35328
    s_waitcnt vmcnt(11)
    s_waitcnt lgkmcnt(10)
    v_mfma_f32_32x32x16_bf16 v[176:191], v[48:51], v[160:163], v[176:191]
    s_add_u32 m0, s95, 24576
    s_add_u32 s92, s79, 57344
    buffer_load_dwordx4 v254, s[96:99], s79 offen lds
    s_cmp_eq_u32 s92, s75
    s_cselect_b32 s79, s78, s92
    ds_read_b64_tr_b16 v[40:41], v26 offset:36864
    ds_read_b64_tr_b16 v[42:43], v26 offset:37376
    s_waitcnt vmcnt(11)
    s_waitcnt lgkmcnt(10)
    v_mfma_f32_32x32x16_bf16 v[176:191], v[52:55], v[164:167], v[176:191]
    s_add_u32 m0, s95, 32768
    s_add_u32 s92, s79, 57344
    buffer_load_dwordx4 v254, s[96:99], s79 offen lds
    s_cmp_eq_u32 s92, s75
    s_cselect_b32 s79, s78, s92
    ds_read_b64_tr_b16 v[44:45], v26 offset:38912
    ds_read_b64_tr_b16 v[46:47], v26 offset:39424
    s_waitcnt vmcnt(11)
    s_waitcnt lgkmcnt(10)
    v_mfma_f32_32x32x16_bf16 v[176:191], v[56:59], v[168:171], v[176:191]
    s_add_u32 m0, s95, 40960
    s_add_u32 s92, s79, 57344
    buffer_load_dwordx4 v254, s[96:99], s79 offen lds
    s_cmp_eq_u32 s92, s75
    s_cselect_b32 s79, s78, s92
    ds_read_b64_tr_b16 v[48:49], v13 offset:57344
    ds_read_b64_tr_b16 v[50:51], v13 offset:57856
    s_waitcnt vmcnt(11)
    s_waitcnt lgkmcnt(10)
    v_mfma_f32_32x32x16_bf16 v[176:191], v[60:63], v[172:175], v[176:191]
    s_add_u32 m0, s95, 114688
    s_add_u32 s92, s79, 57344
    buffer_load_dwordx4 v254, s[96:99], s79 offen lds
    s_cmp_eq_u32 s92, s75
    s_cselect_b32 s79, s78, s92
    ds_read_b64_tr_b16 v[52:53], v13 offset:59392
    ds_read_b64_tr_b16 v[54:55], v13 offset:59904
    s_waitcnt lgkmcnt(10)
    v_mfma_f32_32x32x16_bf16 v[192:207], v[32:35], v[144:147], v[192:207]
    s_add_u32 m0, s95, 122880
    s_add_u32 s92, s79, 57344
    buffer_load_dwordx4 v254, s[96:99], s79 offen lds
    s_cmp_eq_u32 s92, s75
    s_cselect_b32 s79, s78, s92
    ds_read_b64_tr_b16 v[56:57], v13 offset:61440
    ds_read_b64_tr_b16 v[58:59], v13 offset:61952
    s_waitcnt lgkmcnt(10)
    v_mfma_f32_32x32x16_bf16 v[192:207], v[36:39], v[148:151], v[192:207]
    s_nop 3
    v_fmac_f32 v176, v22, v64
    v_fmac_f32 v177, v22, v65
    v_fmac_f32 v178, v22, v66
    v_fmac_f32 v179, v22, v67
    v_fmac_f32 v180, v22, v68
    v_fmac_f32 v181, v22, v69
    v_fmac_f32 v182, v22, v70
    v_fmac_f32 v183, v22, v71
    v_mul_f32 v64, v20, v176
    s_add_u32 m0, s95, 131072
    s_add_u32 s92, s79, 57344
    buffer_load_dwordx4 v254, s[96:99], s79 offen lds
    s_cmp_eq_u32 s92, s75
    s_cselect_b32 s79, s78, s92
    ds_read_b64_tr_b16 v[60:61], v13 offset:63488
    ds_read_b64_tr_b16 v[62:63], v13 offset:64000
    s_waitcnt lgkmcnt(10)
    v_mfma_f32_32x32x16_bf16 v[192:207], v[40:43], v[152:155], v[192:207]
    v_mul_f32 v65, v20, v177
    v_mul_f32 v66, v20, v178
    v_mul_f32 v67, v20, v179
    v_mul_f32 v68, v20, v180
    v_mul_f32 v69, v20, v181
    v_mul_f32 v70, v20, v182
    v_mul_f32 v71, v20, v183
    v_exp_f32 v64, v64
    v_fmac_f32 v184, v22, v72
    v_exp_f32 v65, v65
    s_add_u32 m0, s95, 139264
    s_add_u32 s92, s79, 57344
    buffer_load_dwordx4 v254, s[96:99], s79 offen lds
    s_cmp_eq_u32 s92, s75
    s_cselect_b32 s79, s78, s92
    ds_read_b64_tr_b16 v[32:33], v27 offset:32768
    ds_read_b64_tr_b16 v[34:35], v27 offset:33280
    s_waitcnt lgkmcnt(10)
    v_mfma_f32_32x32x16_bf16 v[192:207], v[44:47], v[156:159], v[192:207]
    v_fmac_f32 v185, v22, v73
    v_exp_f32 v66, v66
    v_fmac_f32 v186, v22, v74
    v_exp_f32 v67, v67
    v_fmac_f32 v187, v22, v75
    v_exp_f32 v68, v68
    v_fmac_f32 v188, v22, v76
    v_exp_f32 v69, v69
    v_fmac_f32 v189, v22, v77
    v_exp_f32 v70, v70
    ds_read_b64_tr_b16 v[36:37], v27 offset:34816
    ds_read_b64_tr_b16 v[38:39], v27 offset:35328
    s_waitcnt lgkmcnt(10)
    v_mfma_f32_32x32x16_bf16 v[192:207], v[48:51], v[160:163], v[192:207]
    v_fmac_f32 v190, v22, v78
    v_exp_f32 v71, v71
    v_fmac_f32 v191, v22, v79
    v_fma_f32 v64, v64, v24, v24
    v_fma_f32 v65, v65, v24, v24
    v_fma_f32 v66, v66, v24, v24
    v_fma_f32 v67, v67, v24, v24
    v_fma_f32 v68, v68, v24, v24
    v_fma_f32 v69, v69, v24, v24
    v_fma_f32 v70, v70, v24, v24
    ds_read_b64_tr_b16 v[40:41], v27 offset:36864
    ds_read_b64_tr_b16 v[42:43], v27 offset:37376
    s_waitcnt lgkmcnt(10)
    v_mfma_f32_32x32x16_bf16 v[192:207], v[52:55], v[164:167], v[192:207]
    v_fma_f32 v71, v71, v24, v24
    v_rcp_f32 v64, v64
    v_mul_f32 v176, v176, v184
    v_rcp_f32 v65, v65
    v_mul_f32 v177, v177, v185
    v_rcp_f32 v66, v66
    v_mul_f32 v178, v178, v186
    v_rcp_f32 v67, v67
    v_mul_f32 v179, v179, v187
    v_rcp_f32 v68, v68
    ds_read_b64_tr_b16 v[44:45], v27 offset:38912
    ds_read_b64_tr_b16 v[46:47], v27 offset:39424
    s_waitcnt lgkmcnt(10)
    v_mfma_f32_32x32x16_bf16 v[192:207], v[56:59], v[168:171], v[192:207]
    v_mul_f32 v180, v180, v188
    v_rcp_f32 v69, v69
    v_mul_f32 v181, v181, v189
    v_rcp_f32 v70, v70
    v_mul_f32 v182, v182, v190
    v_rcp_f32 v71, v71
    v_mul_f32 v183, v183, v191
    v_mul_f32 v176, v176, v64
    v_mul_f32 v177, v177, v65
    v_mul_f32 v178, v178, v66
    ds_read_b64_tr_b16 v[48:49], v14 offset:57344
    ds_read_b64_tr_b16 v[50:51], v14 offset:57856
    s_waitcnt lgkmcnt(10)
    v_mfma_f32_32x32x16_bf16 v[192:207], v[60:63], v[172:175], v[192:207]
    v_mul_f32 v179, v179, v67
    v_mul_f32 v180, v180, v68
    v_mul_f32 v181, v181, v69
    v_mul_f32 v182, v182, v70
    v_mul_f32 v183, v183, v71
    v_cvt_pk_bf16_f32 v72, v176, v177
    v_cvt_pk_bf16_f32 v73, v178, v179
    v_cvt_pk_bf16_f32 v74, v180, v181
    v_cvt_pk_bf16_f32 v75, v182, v183
    s_cmp_eq_u32 s27, 0
    s_cbranch_scc1 L_hs6a
    buffer_store_dwordx4 v[72:75], v251, s[40:43], s59 offen offset:0
    s_branch L_hs6b
L_hs6a:
    buffer_store_dwordx4 v[72:75], v251, s[40:43], s59 offen offset:0 sc1
L_hs6b:
    ds_read_b64_tr_b16 v[52:53], v14 offset:59392
    ds_read_b64_tr_b16 v[54:55], v14 offset:59904
    s_waitcnt lgkmcnt(10)
    v_mfma_f32_32x32x16_bf16 v[208:223], v[32:35], v[144:147], v[208:223]
    ds_read_b64_tr_b16 v[56:57], v14 offset:61440
    ds_read_b64_tr_b16 v[58:59], v14 offset:61952
    s_waitcnt lgkmcnt(10)
    v_mfma_f32_32x32x16_bf16 v[208:223], v[36:39], v[148:151], v[208:223]
    s_nop 3
    v_fmac_f32 v192, v22, v80
    v_fmac_f32 v193, v22, v81
    v_fmac_f32 v194, v22, v82
    v_fmac_f32 v195, v22, v83
    v_fmac_f32 v196, v22, v84
    v_fmac_f32 v197, v22, v85
    v_fmac_f32 v198, v22, v86
    v_fmac_f32 v199, v22, v87
    v_mul_f32 v80, v20, v192
    ds_read_b64_tr_b16 v[60:61], v14 offset:63488
    ds_read_b64_tr_b16 v[62:63], v14 offset:64000
    s_waitcnt lgkmcnt(10)
    v_mfma_f32_32x32x16_bf16 v[208:223], v[40:43], v[152:155], v[208:223]
    v_mul_f32 v81, v20, v193
    v_mul_f32 v82, v20, v194
    v_mul_f32 v83, v20, v195
    v_mul_f32 v84, v20, v196
    v_mul_f32 v85, v20, v197
    v_mul_f32 v86, v20, v198
    v_mul_f32 v87, v20, v199
    v_exp_f32 v80, v80
    v_fmac_f32 v200, v22, v88
    v_exp_f32 v81, v81
    ds_read_b64_tr_b16 v[32:33], v29 offset:32768
    ds_read_b64_tr_b16 v[34:35], v29 offset:33280
    s_waitcnt lgkmcnt(10)
    v_mfma_f32_32x32x16_bf16 v[208:223], v[44:47], v[156:159], v[208:223]
    v_fmac_f32 v201, v22, v89
    v_exp_f32 v82, v82
    v_fmac_f32 v202, v22, v90
    v_exp_f32 v83, v83
    v_fmac_f32 v203, v22, v91
    v_exp_f32 v84, v84
    v_fmac_f32 v204, v22, v92
    v_exp_f32 v85, v85
    v_fmac_f32 v205, v22, v93
    v_exp_f32 v86, v86
    ds_read_b64_tr_b16 v[36:37], v29 offset:34816
    ds_read_b64_tr_b16 v[38:39], v29 offset:35328
    s_waitcnt lgkmcnt(10)
    v_mfma_f32_32x32x16_bf16 v[208:223], v[48:51], v[160:163], v[208:223]
    v_fmac_f32 v206, v22, v94
    v_exp_f32 v87, v87
    v_fmac_f32 v207, v22, v95
    v_fma_f32 v80, v80, v24, v24
    v_fma_f32 v81, v81, v24, v24
    v_fma_f32 v82, v82, v24, v24
    v_fma_f32 v83, v83, v24, v24
    v_fma_f32 v84, v84, v24, v24
    v_fma_f32 v85, v85, v24, v24
    v_fma_f32 v86, v86, v24, v24
    ds_read_b64_tr_b16 v[40:41], v29 offset:36864
    ds_read_b64_tr_b16 v[42:43], v29 offset:37376
    s_waitcnt lgkmcnt(10)
    v_mfma_f32_32x32x16_bf16 v[208:223], v[52:55], v[164:167], v[208:223]
    v_fma_f32 v87, v87, v24, v24
    v_rcp_f32 v80, v80
    v_mul_f32 v192, v192, v200
    v_rcp_f32 v81, v81
    v_mul_f32 v193, v193, v201
    v_rcp_f32 v82, v82
    v_mul_f32 v194, v194, v202
    v_rcp_f32 v83, v83
    v_mul_f32 v195, v195, v203
    v_rcp_f32 v84, v84
    ds_read_b64_tr_b16 v[44:45], v29 offset:38912
    ds_read_b64_tr_b16 v[46:47], v29 offset:39424
    s_waitcnt lgkmcnt(10)
    v_mfma_f32_32x32x16_bf16 v[208:223], v[56:59], v[168:171], v[208:223]
    v_mul_f32 v196, v196, v204
    v_rcp_f32 v85, v85
    v_mul_f32 v197, v197, v205
    v_rcp_f32 v86, v86
    v_mul_f32 v198, v198, v206
    v_rcp_f32 v87, v87
    v_mul_f32 v199, v199, v207
    v_mul_f32 v192, v192, v80
    v_mul_f32 v193, v193, v81
    v_mul_f32 v194, v194, v82
    ds_read_b64_tr_b16 v[48:49], v15 offset:57344
    ds_read_b64_tr_b16 v[50:51], v15 offset:57856
    s_waitcnt lgkmcnt(10)
    v_mfma_f32_32x32x16_bf16 v[208:223], v[60:63], v[172:175], v[208:223]
    v_mul_f32 v195, v195, v83
    v_mul_f32 v196, v196, v84
    v_mul_f32 v197, v197, v85
    v_mul_f32 v198, v198, v86
    v_mul_f32 v199, v199, v87
    v_cvt_pk_bf16_f32 v88, v192, v193
    v_cvt_pk_bf16_f32 v89, v194, v195
    v_cvt_pk_bf16_f32 v90, v196, v197
    v_cvt_pk_bf16_f32 v91, v198, v199
    s_cmp_eq_u32 s27, 0
    s_cbranch_scc1 L_hs7a
    buffer_store_dwordx4 v[88:91], v251, s[40:43], s59 offen offset:1024
    s_branch L_hs7b
L_hs7a:
    buffer_store_dwordx4 v[88:91], v251, s[40:43], s59 offen offset:1024 sc1
L_hs7b:
    ds_read_b64_tr_b16 v[52:53], v15 offset:59392
    ds_read_b64_tr_b16 v[54:55], v15 offset:59904
    s_waitcnt lgkmcnt(10)
    v_mfma_f32_32x32x16_bf16 v[224:239], v[32:35], v[144:147], v[224:239]
    ds_read_b64_tr_b16 v[56:57], v15 offset:61440
    ds_read_b64_tr_b16 v[58:59], v15 offset:61952
    s_waitcnt lgkmcnt(10)
    v_mfma_f32_32x32x16_bf16 v[224:239], v[36:39], v[148:151], v[224:239]
    s_nop 3
    v_fmac_f32 v208, v22, v96
    v_fmac_f32 v209, v22, v97
    v_fmac_f32 v210, v22, v98
    v_fmac_f32 v211, v22, v99
    v_fmac_f32 v212, v22, v100
    v_fmac_f32 v213, v22, v101
    v_fmac_f32 v214, v22, v102
    v_fmac_f32 v215, v22, v103
    v_mul_f32 v96, v20, v208
    ds_read_b64_tr_b16 v[60:61], v15 offset:63488
    ds_read_b64_tr_b16 v[62:63], v15 offset:64000
    s_waitcnt lgkmcnt(10)
    v_mfma_f32_32x32x16_bf16 v[224:239], v[40:43], v[152:155], v[224:239]
    v_mul_f32 v97, v20, v209
    v_mul_f32 v98, v20, v210
    v_mul_f32 v99, v20, v211
    v_mul_f32 v100, v20, v212
    v_mul_f32 v101, v20, v213
    v_mul_f32 v102, v20, v214
    v_mul_f32 v103, v20, v215
    v_exp_f32 v96, v96
    v_fmac_f32 v216, v22, v104
    v_exp_f32 v97, v97
    s_waitcnt lgkmcnt(8)
    v_mfma_f32_32x32x16_bf16 v[224:239], v[44:47], v[156:159], v[224:239]
    v_fmac_f32 v217, v22, v105
    v_exp_f32 v98, v98
    v_fmac_f32 v218, v22, v106
    v_exp_f32 v99, v99
    v_fmac_f32 v219, v22, v107
    v_exp_f32 v100, v100
    v_fmac_f32 v220, v22, v108
    v_exp_f32 v101, v101
    v_fmac_f32 v221, v22, v109
    v_exp_f32 v102, v102
    s_waitcnt lgkmcnt(6)
    v_mfma_f32_32x32x16_bf16 v[224:239], v[48:51], v[160:163], v[224:239]
    v_fmac_f32 v222, v22, v110
    v_exp_f32 v103, v103
    v_fmac_f32 v223, v22, v111
    v_fma_f32 v96, v96, v24, v24
    v_fma_f32 v97, v97, v24, v24
    v_fma_f32 v98, v98, v24, v24
    v_fma_f32 v99, v99, v24, v24
    v_fma_f32 v100, v100, v24, v24
    v_fma_f32 v101, v101, v24, v24
    v_fma_f32 v102, v102, v24, v24
    s_waitcnt lgkmcnt(4)
    v_mfma_f32_32x32x16_bf16 v[224:239], v[52:55], v[164:167], v[224:239]
    v_fma_f32 v103, v103, v24, v24
    v_rcp_f32 v96, v96
    v_mul_f32 v208, v208, v216
    v_rcp_f32 v97, v97
    v_mul_f32 v209, v209, v217
    v_rcp_f32 v98, v98
    v_mul_f32 v210, v210, v218
    v_rcp_f32 v99, v99
    v_mul_f32 v211, v211, v219
    v_rcp_f32 v100, v100
    s_waitcnt lgkmcnt(2)
    v_mfma_f32_32x32x16_bf16 v[224:239], v[56:59], v[168:171], v[224:239]
    v_mul_f32 v212, v212, v220
    v_rcp_f32 v101, v101
    v_mul_f32 v213, v213, v221
    v_rcp_f32 v102, v102
    v_mul_f32 v214, v214, v222
    v_rcp_f32 v103, v103
    v_mul_f32 v215, v215, v223
    v_mul_f32 v208, v208, v96
    v_mul_f32 v209, v209, v97
    v_mul_f32 v210, v210, v98
    s_waitcnt lgkmcnt(0)
    v_mfma_f32_32x32x16_bf16 v[224:239], v[60:63], v[172:175], v[224:239]
    v_mul_f32 v211, v211, v99
    v_mul_f32 v212, v212, v100
    v_mul_f32 v213, v213, v101
    v_mul_f32 v214, v214, v102
    v_mul_f32 v215, v215, v103
    v_cvt_pk_bf16_f32 v104, v208, v209
    v_cvt_pk_bf16_f32 v105, v210, v211
    v_cvt_pk_bf16_f32 v106, v212, v213
    v_cvt_pk_bf16_f32 v107, v214, v215
    s_cmp_eq_u32 s27, 0
    s_cbranch_scc1 L_hs8a
    buffer_store_dwordx4 v[104:107], v251, s[40:43], s59 offen offset:2048
    s_branch L_hs8b
L_hs8a:
    buffer_store_dwordx4 v[104:107], v251, s[40:43], s59 offen offset:2048 sc1
L_hs8b:
    s_nop 7
    s_nop 1
    s_nop 3
    v_fmac_f32 v224, v22, v112
    v_fmac_f32 v225, v22, v113
    v_fmac_f32 v226, v22, v114
    v_fmac_f32 v227, v22, v115
    v_fmac_f32 v228, v22, v116
    v_fmac_f32 v229, v22, v117
    v_fmac_f32 v230, v22, v118
    v_fmac_f32 v231, v22, v119
    v_mul_f32 v112, v20, v224
    v_mul_f32 v113, v20, v225
    v_mul_f32 v114, v20, v226
    v_mul_f32 v115, v20, v227
    v_mul_f32 v116, v20, v228
    v_mul_f32 v117, v20, v229
    v_mul_f32 v118, v20, v230
    v_mul_f32 v119, v20, v231
    v_exp_f32 v112, v112
    v_fmac_f32 v232, v22, v120
    v_exp_f32 v113, v113
    v_fmac_f32 v233, v22, v121
    v_exp_f32 v114, v114
    v_fmac_f32 v234, v22, v122
    v_exp_f32 v115, v115
    v_fmac_f32 v235, v22, v123
    v_exp_f32 v116, v116
    v_fmac_f32 v236, v22, v124
    v_exp_f32 v117, v117
    v_fmac_f32 v237, v22, v125
    v_exp_f32 v118, v118
    v_fmac_f32 v238, v22, v126
    v_exp_f32 v119, v119
    v_fmac_f32 v239, v22, v127
    v_fma_f32 v112, v112, v24, v24
    v_fma_f32 v113, v113, v24, v24
    v_fma_f32 v114, v114, v24, v24
    v_fma_f32 v115, v115, v24, v24
    v_fma_f32 v116, v116, v24, v24
    v_fma_f32 v117, v117, v24, v24
    v_fma_f32 v118, v118, v24, v24
    v_fma_f32 v119, v119, v24, v24
    v_rcp_f32 v112, v112
    v_mul_f32 v224, v224, v232
    v_rcp_f32 v113, v113
    v_mul_f32 v225, v225, v233
    v_rcp_f32 v114, v114
    v_mul_f32 v226, v226, v234
    v_rcp_f32 v115, v115
    v_mul_f32 v227, v227, v235
    v_rcp_f32 v116, v116
    v_mul_f32 v228, v228, v236
    v_rcp_f32 v117, v117
    v_mul_f32 v229, v229, v237
    v_rcp_f32 v118, v118
    v_mul_f32 v230, v230, v238
    v_rcp_f32 v119, v119
    v_mul_f32 v231, v231, v239
    v_mul_f32 v224, v224, v112
    v_mul_f32 v225, v225, v113
    v_mul_f32 v226, v226, v114
    v_mul_f32 v227, v227, v115
    v_mul_f32 v228, v228, v116
    v_mul_f32 v229, v229, v117
    v_mul_f32 v230, v230, v118
    v_mul_f32 v231, v231, v119
    v_cvt_pk_bf16_f32 v120, v224, v225
    v_cvt_pk_bf16_f32 v121, v226, v227
    v_cvt_pk_bf16_f32 v122, v228, v229
    v_cvt_pk_bf16_f32 v123, v230, v231
    s_cmp_eq_u32 s27, 0
    s_cbranch_scc1 L_hs9a
    buffer_store_dwordx4 v[120:123], v251, s[40:43], s59 offen offset:3072
    s_branch L_hs9b
L_hs9a:
    buffer_store_dwordx4 v[120:123], v251, s[40:43], s59 offen offset:3072 sc1
L_hs9b:
    s_nop 1
    s_waitcnt vmcnt(0)
    s_barrier
    s_cmp_lg_u32 s24, 1
    s_cbranch_scc1 L_kb_s4_nosig
    v_mov_b32 v2, 1
    v_mov_b32 v3, 0
    s_mov_b64 exec, 1
    s_cmp_eq_u32 s27, 0
    s_cbranch_scc1 L_hs10a
    buffer_store_dword v2, v3, s[28:31], s35 offen
    s_branch L_hs10b
L_hs10a:
    buffer_store_dword v2, v3, s[28:31], s35 offen sc1
L_hs10b:
    s_mov_b64 exec, -1
L_kb_s4_nosig:
    s_and_b32 s36, s24, 3
    s_lshr_b32 s37, s24, 2
    s_lshr_b32 s38, s36, 1
    s_and_b32 s39, s36, 1
    v_lshrrev_b32 v4, 5, v1
    v_bfe_u32 v5, v1, 2, 2
    v_lshl_add_u32 v8, v4, 3, v5
    v_lshlrev_b32 v8, 7, v8
    v_lshrrev_b32 v5, 1, v5
    v_xor_b32 v5, s38, v5
    v_lshl_add_u32 v8, v5, 6, v8
    v_bfe_u32 v5, v1, 4, 1
    v_xor_b32 v5, s39, v5
    v_lshl_add_u32 v8, v5, 5, v8
    v_and_b32 v5, 1, v1
    v_lshl_add_u32 v8, v5, 4, v8
    v_bfe_u32 v5, v1, 1, 1
    v_lshl_add_u32 v8, v5, 3, v8
    s_lshl_b32 s40, s36, 11
    v_add_u32 v8, s40, v8
    v_xor_b32 v9, 64, v8
    v_add_u32 v10, 0x10000, v8
    v_add_u32 v11, 0x10000, v9
    v_add_u32 v12, 0x20000, v8
    v_add_u32 v13, 0x20000, v9
    s_add_u32 s48, s22, 10485760
    s_addc_u32 s49, s23, 0
    s_and_b32 s49, s49, 0xffff
    s_mov_b32 s50, 7340032
    s_mov_b32 s51, 0x00020000
    s_add_u32 s52, s22, 8388608
    s_addc_u32 s53, s23, 0
    s_and_b32 s53, s53, 0xffff
    s_mov_b32 s54, 1835008
    s_mov_b32 s55, 0x00020000
    s_mov_b32 s56, s18
    s_mov_b32 s57, s19
    s_and_b32 s57, s57, 0xffff
    s_mov_b32 s58, 1835008
    s_mov_b32 s59, 0x00020000
    s_lshl_b32 s40, s88, 1
    s_add_u32 s40, s40, s37
    s_mul_i32 s41, s40, 114688
    s_lshl_b32 s42, s36, 10
    s_add_u32 s41, s41, s42
    s_add_u32 s43, s41, 114688
    s_lshl_b32 s42, s93, 12
    s_add_u32 s42, s42, s41
    s_mul_i32 s45, s40, 28672
    s_lshl_b32 s46, s89, 12
    s_add_u32 s45, s45, s46
    s_lshl_b32 s46, s36, 10
    s_add_u32 s45, s45, s46
    s_mul_i32 s46, s37, 24576
    s_add_u32 s46, s46, 114688
    s_mul_i32 s47, s36, 6144
    s_add_u32 s47, s47, s46
    v_add_u32 v24, s47, v251
    s_xor_b32 s47, s36, 1
    s_mul_i32 s47, s47, 6144
    s_add_u32 s47, s47, s46
    v_add_u32 v25, s47, v251
    s_xor_b32 s47, s36, 2
    s_mul_i32 s47, s47, 6144
    s_add_u32 s47, s47, s46
    v_add_u32 v26, s47, v251
    s_xor_b32 s47, s36, 3
    s_mul_i32 s47, s47, 6144
    s_add_u32 s47, s47, s46
    v_add_u32 v27, s47, v251
    buffer_load_dwordx4 v[16:19], v251, s[52:55], s45 offen
    s_add_u32 m0, s95, 147456
    s_add_u32 s92, s79, 57344
    buffer_load_dwordx4 v254, s[96:99], s79 offen lds
    s_cmp_eq_u32 s92, s75
    s_cselect_b32 s79, s78, s92
    s_add_u32 m0, s95, 155648
    s_add_u32 s92, s79, 57344
    buffer_load_dwordx4 v254, s[96:99], s79 offen lds
    s_cmp_eq_u32 s92, s75
    s_cselect_b32 s79, s78, s92
    s_add_u32 m0, s95, 57344
    s_add_u32 s92, s79, 57344
    buffer_load_dwordx4 v254, s[96:99], s79 offen lds
    s_cmp_eq_u32 s92, s75
    s_cselect_b32 s79, s78, s92
    s_add_u32 m0, s95, 65536
    s_add_u32 s92, s79, 57344
    buffer_load_dwordx4 v254, s[96:99], s79 offen lds
    s_cmp_eq_u32 s92, s75
    s_cselect_b32 s79, s78, s92
    ds_read_b64_tr_b16 v[160:161], v10 offset:8192
    ds_read_b64_tr_b16 v[162:163], v10 offset:8704
    ds_read_b64_tr_b16 v[164:165], v11 offset:8192
    ds_read_b64_tr_b16 v[166:167], v11 offset:8704
    ds_read_b64_tr_b16 v[168:169], v10 offset:16384
    ds_read_b64_tr_b16 v[170:171], v10 offset:16896
    ds_read_b64_tr_b16 v[172:173], v11 offset:16384
    ds_read_b64_tr_b16 v[174:175], v11 offset:16896
    ds_read_b64_tr_b16 v[176:177], v10 offset:24576
    ds_read_b64_tr_b16 v[178:179], v10 offset:25088
    ds_read_b64_tr_b16 v[180:181], v11 offset:24576
    ds_read_b64_tr_b16 v[182:183], v11 offset:25088
    s_waitcnt lgkmcnt(0)
    ds_read_b64_tr_b16 v[184:185], v10 offset:32768
    ds_read_b64_tr_b16 v[186:187], v10 offset:33280
    ds_read_b64_tr_b16 v[188:189], v11 offset:32768
    ds_read_b64_tr_b16 v[190:191], v11 offset:33280
    ds_read_b64_tr_b16 v[192:193], v10 offset:40960
    ds_read_b64_tr_b16 v[194:195], v10 offset:41472
    ds_read_b64_tr_b16 v[196:197], v11 offset:40960
    ds_read_b64_tr_b16 v[198:199], v11 offset:41472
    ds_read_b64_tr_b16 v[200:201], v8 offset:0
    ds_read_b64_tr_b16 v[202:203], v8 offset:512
    ds_read_b64_tr_b16 v[204:205], v9 offset:0
    ds_read_b64_tr_b16 v[206:207], v9 offset:512
    s_waitcnt lgkmcnt(0)
    ds_read_b64_tr_b16 v[208:209], v8 offset:8192
    ds_read_b64_tr_b16 v[210:211], v8 offset:8704
    ds_read_b64_tr_b16 v[212:213], v9 offset:8192
    ds_read_b64_tr_b16 v[214:215], v9 offset:8704
    ds_read_b64_tr_b16 v[216:217], v8 offset:16384
    ds_read_b64_tr_b16 v[218:219], v8 offset:16896
    ds_read_b64_tr_b16 v[220:221], v9 offset:16384
    ds_read_b64_tr_b16 v[222:223], v9 offset:16896
    ds_read_b64_tr_b16 v[224:225], v8 offset:24576
    ds_read_b64_tr_b16 v[226:227], v8 offset:25088
    ds_read_b64_tr_b16 v[228:229], v9 offset:24576
    ds_read_b64_tr_b16 v[230:231], v9 offset:25088
    s_waitcnt lgkmcnt(0)
    s_barrier
    s_add_u32 m0, s95, 73728
    s_add_u32 s92, s79, 57344
    buffer_load_dwordx4 v254, s[96:99], s79 offen lds
    s_cmp_eq_u32 s92, s75
    s_cselect_b32 s79, s78, s92
    s_add_u32 m0, s95, 81920
    s_add_u32 s92, s79, 57344
    buffer_load_dwordx4 v254, s[96:99], s79 offen lds
    s_cmp_eq_u32 s92, s75
    s_cselect_b32 s79, s78, s92
    s_add_u32 m0, s95, 90112
    s_add_u32 s92, s79, 57344
    buffer_load_dwordx4 v254, s[96:99], s79 offen lds
    s_cmp_eq_u32 s92, s75
    s_cselect_b32 s79, s78, s92
    s_add_u32 m0, s95, 98304
    s_add_u32 s92, s79, 57344
    buffer_load_dwordx4 v254, s[96:99], s79 offen lds
    s_cmp_eq_u32 s92, s75
    s_cselect_b32 s79, s78, s92
    s_add_u32 m0, s95, 106496
    s_add_u32 s92, s79, 57344
    buffer_load_dwordx4 v254, s[96:99], s79 offen lds
    s_cmp_eq_u32 s92, s75
    s_cselect_b32 s79, s78, s92
    s_add_u32 m0, s95, 0
    s_add_u32 s92, s79, 57344
    buffer_load_dwordx4 v254, s[96:99], s79 offen lds
    s_cmp_eq_u32 s92, s75
    s_cselect_b32 s79, s78, s92
    s_add_u32 m0, s95, 8192
    s_add_u32 s92, s79, 57344
    buffer_load_dwordx4 v254, s[96:99], s79 offen lds
    s_cmp_eq_u32 s92, s75
    s_cselect_b32 s79, s78, s92
    s_add_u32 m0, s95, 16384
    s_add_u32 s92, s79, 57344
    buffer_load_dwordx4 v254, s[96:99], s79 offen lds
    s_cmp_eq_u32 s92, s75
    s_cselect_b32 s79, s78, s92
    s_add_u32 m0, s95, 24576
    s_add_u32 s92, s79, 57344
    buffer_load_dwordx4 v254, s[96:99], s79 offen lds
    s_cmp_eq_u32 s92, s75
    s_cselect_b32 s79, s78, s92
    s_add_u32 s46, s74, 3072
    s_mov_b32 s47, 0xffff0000
    s_cmp_lg_u32 s24, 0
    s_cbranch_scc1 L_kb_w4_pw
    s_mov_b32 exec_lo, 268435455
    s_mov_b32 exec_hi, 0
    s_mov_b32 s101, 0
L_kb_w4_pl:
    buffer_load_dword v2, v250, s[28:31], s46 offen sc1
    s_add_u32 s101, s101, 1
    s_waitcnt vmcnt(0)
    v_cmp_eq_u32 vcc, 0, v2
    s_cmp_gt_u32 s101, 200000
    s_cbranch_scc1 L_kb_w4_pd
    s_nop 3
    s_cbranch_vccz L_kb_w4_pd
    s_sleep 1
    s_branch L_kb_w4_pl
L_kb_w4_pd:
    s_mov_b64 exec, -1
L_kb_w4_pw:
    s_barrier
    s_add_u32 s46, s42, 4096
    buffer_load_dwordx4 v[96:99], v251, s[48:51], s42 offen sc1
    s_cmp_eq_u32 s46, s43
    s_cselect_b32 s42, s41, s46
    s_add_u32 s46, s42, 4096
    buffer_load_dwordx4 v[100:103], v251, s[48:51], s42 offen sc1
    s_cmp_eq_u32 s46, s43
    s_cselect_b32 s42, s41, s46
    s_add_u32 s46, s42, 4096
    buffer_load_dwordx4 v[104:107], v251, s[48:51], s42 offen sc1
    s_cmp_eq_u32 s46, s43
    s_cselect_b32 s42, s41, s46
    s_add_u32 s46, s42, 4096
    buffer_load_dwordx4 v[108:111], v251, s[48:51], s42 offen sc1
    s_cmp_eq_u32 s46, s43
    s_cselect_b32 s42, s41, s46
    s_add_u32 s46, s42, 4096
    buffer_load_dwordx4 v[112:115], v251, s[48:51], s42 offen sc1
    s_cmp_eq_u32 s46, s43
    s_cselect_b32 s42, s41, s46
    s_add_u32 s46, s42, 4096
    buffer_load_dwordx4 v[116:119], v251, s[48:51], s42 offen sc1
    s_cmp_eq_u32 s46, s43
    s_cselect_b32 s42, s41, s46
    s_waitcnt vmcnt(5)
    v_mfma_f32_32x32x16_bf16 v[32:47], v[160:163], v[96:99], 0
    v_mfma_f32_32x32x16_bf16 v[48:63], v[164:167], v[96:99], 0
    s_add_u32 s46, s42, 4096
    buffer_load_dwordx4 v[120:123], v251, s[48:51], s42 offen sc1
    s_cmp_eq_u32 s46, s43
    s_cselect_b32 s42, s41, s46
    s_waitcnt vmcnt(5)
    v_mfma_f32_32x32x16_bf16 v[32:47], v[168:171], v[100:103], v[32:47]
    v_mfma_f32_32x32x16_bf16 v[48:63], v[172:175], v[100:103], v[48:63]
    s_add_u32 s46, s42, 4096
    buffer_load_dwordx4 v[124:127], v251, s[48:51], s42 offen sc1
    s_cmp_eq_u32 s46, s43
    s_cselect_b32 s42, s41, s46
    s_waitcnt vmcnt(5)
    v_mfma_f32_32x32x16_bf16 v[32:47], v[176:179], v[104:107], v[32:47]
    v_mfma_f32_32x32x16_bf16 v[48:63], v[180:183], v[104:107], v[48:63]
    s_add_u32 s46, s42, 4096
    buffer_load_dwordx4 v[128:131], v251, s[48:51], s42 offen sc1
    s_cmp_eq_u32 s46, s43
    s_cselect_b32 s42, s41, s46
    s_waitcnt vmcnt(5)
    v_mfma_f32_32x32x16_bf16 v[32:47], v[184:187], v[108:111], v[32:47]
    v_mfma_f32_32x32x16_bf16 v[48:63], v[188:191], v[108:111], v[48:63]
    s_add_u32 s46, s42, 4096
    buffer_load_dwordx4 v[132:135], v251, s[48:51], s42 offen sc1
    s_cmp_eq_u32 s46, s43
    s_cselect_b32 s42, s41, s46
    s_waitcnt vmcnt(5)
    v_mfma_f32_32x32x16_bf16 v[32:47], v[192:195], v[112:115], v[32:47]
    v_mfma_f32_32x32x16_bf16 v[48:63], v[196:199], v[112:115], v[48:63]
    s_add_u32 s46, s42, 4096
    buffer_load_dwordx4 v[136:139], v251, s[48:51], s42 offen sc1
    s_cmp_eq_u32 s46, s43
    s_cselect_b32 s42, s41, s46
    s_waitcnt vmcnt(5)
    v_mfma_f32_32x32x16_bf16 v[32:47], v[200:203], v[116:119], v[32:47]
    v_mfma_f32_32x32x16_bf16 v[48:63], v[204:207], v[116:119], v[48:63]
    s_add_u32 s46, s42, 4096
    buffer_load_dwordx4 v[140:143], v251, s[48:51], s42 offen sc1
    s_cmp_eq_u32 s46, s43
    s_cselect_b32 s42, s41, s46
    s_waitcnt vmcnt(5)
    v_mfma_f32_32x32x16_bf16 v[32:47], v[208:211], v[120:123], v[32:47]
    v_mfma_f32_32x32x16_bf16 v[48:63], v[212:215], v[120:123], v[48:63]
    s_add_u32 s46, s42, 4096
    buffer_load_dwordx4 v[144:147], v251, s[48:51], s42 offen sc1
    s_cmp_eq_u32 s46, s43
    s_cselect_b32 s42, s41, s46
    s_waitcnt vmcnt(5)
    v_mfma_f32_32x32x16_bf16 v[32:47], v[216:219], v[124:127], v[32:47]
    v_mfma_f32_32x32x16_bf16 v[48:63], v[220:223], v[124:127], v[48:63]
    s_add_u32 s46, s42, 4096
    buffer_load_dwordx4 v[148:151], v251, s[48:51], s42 offen sc1
    s_cmp_eq_u32 s46, s43
    s_cselect_b32 s42, s41, s46
    ds_read_b64_tr_b16 v[72:73], v8 offset:32768
    ds_read_b64_tr_b16 v[74:75], v8 offset:33280
    ds_read_b64_tr_b16 v[76:77], v9 offset:32768
    ds_read_b64_tr_b16 v[78:79], v9 offset:33280
    s_waitcnt vmcnt(5)
    v_mfma_f32_32x32x16_bf16 v[32:47], v[224:227], v[128:131], v[32:47]
    v_mfma_f32_32x32x16_bf16 v[48:63], v[228:231], v[128:131], v[48:63]
    s_add_u32 s46, s42, 4096
    buffer_load_dwordx4 v[152:155], v251, s[48:51], s42 offen sc1
    s_cmp_eq_u32 s46, s43
    s_cselect_b32 s42, s41, s46
    ds_read_b64_tr_b16 v[64:65], v8 offset:40960
    ds_read_b64_tr_b16 v[66:67], v8 offset:41472
    ds_read_b64_tr_b16 v[68:69], v9 offset:40960
    ds_read_b64_tr_b16 v[70:71], v9 offset:41472
    s_waitcnt vmcnt(5)
    s_waitcnt lgkmcnt(4)
    v_mfma_f32_32x32x16_bf16 v[32:47], v[72:75], v[132:135], v[32:47]
    v_mfma_f32_32x32x16_bf16 v[48:63], v[76:79], v[132:135], v[48:63]
    s_add_u32 s46, s42, 4096
    buffer_load_dwordx4 v[156:159], v251, s[48:51], s42 offen sc1
    s_cmp_eq_u32 s46, s43
    s_cselect_b32 s42, s41, s46
    ds_read_b64_tr_b16 v[72:73], v10 offset:49152
    ds_read_b64_tr_b16 v[74:75], v10 offset:49664
    ds_read_b64_tr_b16 v[76:77], v11 offset:49152
    ds_read_b64_tr_b16 v[78:79], v11 offset:49664
    s_waitcnt vmcnt(5)
    s_waitcnt lgkmcnt(4)
    v_mfma_f32_32x32x16_bf16 v[32:47], v[64:67], v[136:139], v[32:47]
    v_mfma_f32_32x32x16_bf16 v[48:63], v[68:71], v[136:139], v[48:63]
    s_add_u32 s46, s42, 4096
    buffer_load_dwordx4 v[96:99], v251, s[48:51], s42 offen sc1
    s_cmp_eq_u32 s46, s43
    s_cselect_b32 s42, s41, s46
    ds_read_b64_tr_b16 v[64:65], v10 offset:57344
    ds_read_b64_tr_b16 v[66:67], v10 offset:57856
    ds_read_b64_tr_b16 v[68:69], v11 offset:57344
    ds_read_b64_tr_b16 v[70:71], v11 offset:57856
    s_waitcnt vmcnt(5)
    s_waitcnt lgkmcnt(4)
    v_mfma_f32_32x32x16_bf16 v[32:47], v[72:75], v[140:143], v[32:47]
    v_mfma_f32_32x32x16_bf16 v[48:63], v[76:79], v[140:143], v[48:63]
    s_add_u32 s46, s42, 4096
    buffer_load_dwordx4 v[100:103], v251, s[48:51], s42 offen sc1
    s_cmp_eq_u32 s46, s43
    s_cselect_b32 s42, s41, s46
    ds_read_b64_tr_b16 v[72:73], v12 offset:0
    ds_read_b64_tr_b16 v[74:75], v12 offset:512
    ds_read_b64_tr_b16 v[76:77], v13 offset:0
    ds_read_b64_tr_b16 v[78:79], v13 offset:512
    s_waitcnt vmcnt(5)
    s_waitcnt lgkmcnt(4)
    v_mfma_f32_32x32x16_bf16 v[32:47], v[64:67], v[144:147], v[32:47]
    v_mfma_f32_32x32x16_bf16 v[48:63], v[68:71], v[144:147], v[48:63]
    s_add_u32 s46, s42, 4096
    buffer_load_dwordx4 v[104:107], v251, s[48:51], s42 offen sc1
    s_cmp_eq_u32 s46, s43
    s_cselect_b32 s42, s41, s46
    ds_read_b64_tr_b16 v[64:65], v12 offset:8192
    ds_read_b64_tr_b16 v[66:67], v12 offset:8704
    ds_read_b64_tr_b16 v[68:69], v13 offset:8192
    ds_read_b64_tr_b16 v[70:71], v13 offset:8704
    s_waitcnt vmcnt(5)
    s_waitcnt lgkmcnt(4)
    v_mfma_f32_32x32x16_bf16 v[32:47], v[72:75], v[148:151], v[32:47]
    v_mfma_f32_32x32x16_bf16 v[48:63], v[76:79], v[148:151], v[48:63]
    s_add_u32 s46, s42, 4096
    buffer_load_dwordx4 v[108:111], v251, s[48:51], s42 offen sc1
    s_cmp_eq_u32 s46, s43
    s_cselect_b32 s42, s41, s46
    s_barrier
    ds_read_b64_tr_b16 v[72:73], v12 offset:16384
    ds_read_b64_tr_b16 v[74:75], v12 offset:16896
    ds_read_b64_tr_b16 v[76:77], v13 offset:16384
    ds_read_b64_tr_b16 v[78:79], v13 offset:16896
    s_waitcnt vmcnt(5)
    s_waitcnt lgkmcnt(4)
    v_mfma_f32_32x32x16_bf16 v[32:47], v[64:67], v[152:155], v[32:47]
    v_mfma_f32_32x32x16_bf16 v[48:63], v[68:71], v[152:155], v[48:63]
    s_add_u32 s46, s42, 4096
    buffer_load_dwordx4 v[112:115], v251, s[48:51], s42 offen sc1
    s_cmp_eq_u32 s46, s43
    s_cselect_b32 s42, s41, s46
    ds_read_b64_tr_b16 v[64:65], v12 offset:24576
    ds_read_b64_tr_b16 v[66:67], v12 offset:25088
    ds_read_b64_tr_b16 v[68:69], v13 offset:24576
    ds_read_b64_tr_b16 v[70:71], v13 offset:25088
    s_waitcnt vmcnt(5)
    s_waitcnt lgkmcnt(4)
    v_mfma_f32_32x32x16_bf16 v[32:47], v[72:75], v[156:159], v[32:47]
    v_mfma_f32_32x32x16_bf16 v[48:63], v[76:79], v[156:159], v[48:63]
    s_add_u32 s46, s42, 4096
    buffer_load_dwordx4 v[116:119], v251, s[48:51], s42 offen sc1
    s_cmp_eq_u32 s46, s43
    s_cselect_b32 s42, s41, s46
    ds_read_b64_tr_b16 v[72:73], v8 offset:57344
    ds_read_b64_tr_b16 v[74:75], v8 offset:57856
    ds_read_b64_tr_b16 v[76:77], v9 offset:57344
    ds_read_b64_tr_b16 v[78:79], v9 offset:57856
    s_waitcnt vmcnt(5)
    s_waitcnt lgkmcnt(4)
    v_mfma_f32_32x32x16_bf16 v[32:47], v[64:67], v[96:99], v[32:47]
    v_mfma_f32_32x32x16_bf16 v[48:63], v[68:71], v[96:99], v[48:63]
    s_add_u32 s46, s42, 4096
    buffer_load_dwordx4 v[120:123], v251, s[48:51], s42 offen sc1
    s_cmp_eq_u32 s46, s43
    s_cselect_b32 s42, s41, s46
    ds_read_b64_tr_b16 v[64:65], v10 offset:0
    ds_read_b64_tr_b16 v[66:67], v10 offset:512
    ds_read_b64_tr_b16 v[68:69], v11 offset:0
    ds_read_b64_tr_b16 v[70:71], v11 offset:512
    s_waitcnt vmcnt(5)
    s_waitcnt lgkmcnt(4)
    v_mfma_f32_32x32x16_bf16 v[32:47], v[72:75], v[100:103], v[32:47]
    v_mfma_f32_32x32x16_bf16 v[48:63], v[76:79], v[100:103], v[48:63]
    s_add_u32 s46, s42, 4096
    buffer_load_dwordx4 v[124:127], v251, s[48:51], s42 offen sc1
    s_cmp_eq_u32 s46, s43
    s_cselect_b32 s42, s41, s46
    s_barrier
    ds_read_b64_tr_b16 v[72:73], v10 offset:8192
    ds_read_b64_tr_b16 v[74:75], v10 offset:8704
    ds_read_b64_tr_b16 v[76:77], v11 offset:8192
    ds_read_b64_tr_b16 v[78:79], v11 offset:8704
    s_waitcnt vmcnt(5)
    s_waitcnt lgkmcnt(4)
    v_mfma_f32_32x32x16_bf16 v[32:47], v[64:67], v[104:107], v[32:47]
    v_mfma_f32_32x32x16_bf16 v[48:63], v[68:71], v[104:107], v[48:63]
    s_add_u32 s46, s42, 4096
    buffer_load_dwordx4 v[128:131], v251, s[48:51], s42 offen sc1
    s_cmp_eq_u32 s46, s43
    s_cselect_b32 s42, s41, s46
    ds_read_b64_tr_b16 v[64:65], v10 offset:16384
    ds_read_b64_tr_b16 v[66:67], v10 offset:16896
    ds_read_b64_tr_b16 v[68:69], v11 offset:16384
    ds_read_b64_tr_b16 v[70:71], v11 offset:16896
    s_waitcnt vmcnt(5)
    s_waitcnt lgkmcnt(4)
    v_mfma_f32_32x32x16_bf16 v[32:47], v[72:75], v[108:111], v[32:47]
    v_mfma_f32_32x32x16_bf16 v[48:63], v[76:79], v[108:111], v[48:63]
    s_add_u32 s46, s42, 4096
    buffer_load_dwordx4 v[132:135], v251, s[48:51], s42 offen sc1
    s_cmp_eq_u32 s46, s43
    s_cselect_b32 s42, s41, s46
    ds_read_b64_tr_b16 v[72:73], v10 offset:24576
    ds_read_b64_tr_b16 v[74:75], v10 offset:25088
    ds_read_b64_tr_b16 v[76:77], v11 offset:24576
    ds_read_b64_tr_b16 v[78:79], v11 offset:25088
    s_waitcnt vmcnt(5)
    s_waitcnt lgkmcnt(4)
    v_mfma_f32_32x32x16_bf16 v[32:47], v[64:67], v[112:115], v[32:47]
    v_mfma_f32_32x32x16_bf16 v[48:63], v[68:71], v[112:115], v[48:63]
    s_add_u32 s46, s42, 4096
    buffer_load_dwordx4 v[136:139], v251, s[48:51], s42 offen sc1
    s_cmp_eq_u32 s46, s43
    s_cselect_b32 s42, s41, s46
    ds_read_b64_tr_b16 v[64:65], v10 offset:32768
    ds_read_b64_tr_b16 v[66:67], v10 offset:33280
    ds_read_b64_tr_b16 v[68:69], v11 offset:32768
    ds_read_b64_tr_b16 v[70:71], v11 offset:33280
    s_waitcnt vmcnt(5)
    s_waitcnt lgkmcnt(4)
    v_mfma_f32_32x32x16_bf16 v[32:47], v[72:75], v[116:119], v[32:47]
    v_mfma_f32_32x32x16_bf16 v[48:63], v[76:79], v[116:119], v[48:63]
    s_add_u32 s46, s42, 4096
    buffer_load_dwordx4 v[140:143], v251, s[48:51], s42 offen sc1
    s_cmp_eq_u32 s46, s43
    s_cselect_b32 s42, s41, s46
    ds_read_b64_tr_b16 v[72:73], v10 offset:40960
    ds_read_b64_tr_b16 v[74:75], v10 offset:41472
    ds_read_b64_tr_b16 v[76:77], v11 offset:40960
    ds_read_b64_tr_b16 v[78:79], v11 offset:41472
    s_waitcnt vmcnt(5)
    s_waitcnt lgkmcnt(4)
    v_mfma_f32_32x32x16_bf16 v[32:47], v[64:67], v[120:123], v[32:47]
    v_mfma_f32_32x32x16_bf16 v[48:63], v[68:71], v[120:123], v[48:63]
    ds_read_b64_tr_b16 v[64:65], v8 offset:0
    ds_read_b64_tr_b16 v[66:67], v8 offset:512
    ds_read_b64_tr_b16 v[68:69], v9 offset:0
    ds_read_b64_tr_b16 v[70:71], v9 offset:512
    s_waitcnt vmcnt(4)
    s_waitcnt lgkmcnt(4)
    v_mfma_f32_32x32x16_bf16 v[32:47], v[72:75], v[124:127], v[32:47]
    v_mfma_f32_32x32x16_bf16 v[48:63], v[76:79], v[124:127], v[48:63]
    ds_read_b64_tr_b16 v[72:73], v8 offset:8192
    ds_read_b64_tr_b16 v[74:75], v8 offset:8704
    ds_read_b64_tr_b16 v[76:77], v9 offset:8192
    ds_read_b64_tr_b16 v[78:79], v9 offset:8704
    s_waitcnt vmcnt(3)
    s_waitcnt lgkmcnt(4)
    v_mfma_f32_32x32x16_bf16 v[32:47], v[64:67], v[128:131], v[32:47]
    v_mfma_f32_32x32x16_bf16 v[48:63], v[68:71], v[128:131], v[48:63]
    ds_read_b64_tr_b16 v[64:65], v8 offset:16384
    ds_read_b64_tr_b16 v[66:67], v8 offset:16896
    ds_read_b64_tr_b16 v[68:69], v9 offset:16384
    ds_read_b64_tr_b16 v[70:71], v9 offset:16896
    s_waitcnt vmcnt(2)
    s_waitcnt lgkmcnt(4)
    v_mfma_f32_32x32x16_bf16 v[32:47], v[72:75], v[132:135], v[32:47]
    v_mfma_f32_32x32x16_bf16 v[48:63], v[76:79], v[132:135], v[48:63]
    ds_read_b64_tr_b16 v[72:73], v8 offset:24576
    ds_read_b64_tr_b16 v[74:75], v8 offset:25088
    ds_read_b64_tr_b16 v[76:77], v9 offset:24576
    ds_read_b64_tr_b16 v[78:79], v9 offset:25088
    s_waitcnt vmcnt(1)
    s_waitcnt lgkmcnt(4)
    v_mfma_f32_32x32x16_bf16 v[32:47], v[64:67], v[136:139], v[32:47]
    v_mfma_f32_32x32x16_bf16 v[48:63], v[68:71], v[136:139], v[48:63]
    s_waitcnt vmcnt(0)
    s_waitcnt lgkmcnt(0)
    v_mfma_f32_32x32x16_bf16 v[32:47], v[72:75], v[140:143], v[32:47]
    v_mfma_f32_32x32x16_bf16 v[48:63], v[76:79], v[140:143], v[48:63]
    s_nop 7
    s_nop 3
    ds_write_b128 v24, v[40:43] offset:0
    ds_write_b128 v24, v[44:47] offset:1024
    ds_write_b128 v24, v[48:51] offset:2048
    ds_write_b128 v24, v[52:55] offset:3072
    ds_write_b128 v24, v[56:59] offset:4096
    ds_write_b128 v24, v[60:63] offset:5120
    v_lshlrev_b32 v64, 16, v16
    v_and_b32 v65, s47, v16
    v_lshlrev_b32 v66, 16, v17
    v_and_b32 v67, s47, v17
    v_lshlrev_b32 v68, 16, v18
    v_and_b32 v69, s47, v18
    v_lshlrev_b32 v70, 16, v19
    v_and_b32 v71, s47, v19
    v_pk_add_f32 v[32:33], v[32:33], v[64:65]
    v_pk_add_f32 v[34:35], v[34:35], v[66:67]
    v_pk_add_f32 v[36:37], v[36:37], v[68:69]
    v_pk_add_f32 v[38:39], v[38:39], v[70:71]
    s_waitcnt lgkmcnt(0)
    s_barrier
    ds_read_b128 v[104:107], v25 offset:0
    ds_read_b128 v[108:111], v25 offset:1024
    ds_read_b128 v[112:115], v26 offset:2048
    ds_read_b128 v[116:119], v26 offset:3072
    ds_read_b128 v[120:123], v27 offset:4096
    ds_read_b128 v[124:127], v27 offset:5120
    s_waitcnt lgkmcnt(4)
    v_pk_add_f32 v[32:33], v[32:33], v[104:105]
    v_pk_add_f32 v[34:35], v[34:35], v[106:107]
    v_pk_add_f32 v[36:37], v[36:37], v[108:109]
    v_pk_add_f32 v[38:39], v[38:39], v[110:111]
    s_waitcnt lgkmcnt(2)
    v_pk_add_f32 v[32:33], v[32:33], v[112:113]
    v_pk_add_f32 v[34:35], v[34:35], v[114:115]
    v_pk_add_f32 v[36:37], v[36:37], v[116:117]
    v_pk_add_f32 v[38:39], v[38:39], v[118:119]
    s_waitcnt lgkmcnt(0)
    v_pk_add_f32 v[32:33], v[32:33], v[120:121]
    v_pk_add_f32 v[34:35], v[34:35], v[122:123]
    v_pk_add_f32 v[36:37], v[36:37], v[124:125]
    v_pk_add_f32 v[38:39], v[38:39], v[126:127]
    v_cvt_pk_bf16_f32 v16, v32, v33
    v_cvt_pk_bf16_f32 v17, v34, v35
    v_cvt_pk_bf16_f32 v18, v36, v37
    v_cvt_pk_bf16_f32 v19, v38, v39
    buffer_store_dwordx4 v[16:19], v249, s[56:59], s73 offen
L_kb_end:
    s_endpgm
L_kb_spare2:
    v_lshlrev_b32 v9, 7, v1
    s_sub_u32 s36, s26, 28
    s_lshl_b32 s36, s36, 3
    s_add_u32 s36, s36, s24
    s_bitcmp1_b32 s36, 0
    s_cselect_b32 s80, s84, s80
    s_cselect_b32 s81, s85, s81
    s_lshr_b32 s37, s36, 1
    s_lshl_b32 s37, s37, 13
    s_add_u32 s38, s37, 917504
    buffer_load_dword v30, v9, s[80:83], s38 offen
    s_add_u32 s38, s37, 1048576
    buffer_load_dword v31, v9, s[80:83], s38 offen
    s_add_u32 s38, s37, 1179648
    buffer_load_dword v32, v9, s[80:83], s38 offen
    s_add_u32 s38, s37, 1310720
    buffer_load_dword v33, v9, s[80:83], s38 offen
    s_add_u32 s38, s37, 1441792
    buffer_load_dword v34, v9, s[80:83], s38 offen
    s_add_u32 s38, s37, 1572864
    buffer_load_dword v35, v9, s[80:83], s38 offen
    s_mov_b32 s96, s16
    s_mov_b32 s97, s17
    s_and_b32 s97, s97, 0xffff
    s_mov_b32 s98, 1605632
    s_mov_b32 s99, 0x00020000
    s_lshl_b32 s39, s36, 13
    s_add_u32 s38, s39, 0
    buffer_load_dword v40, v9, s[96:99], s38 offen
    s_add_u32 s38, s39, 262144
    buffer_load_dword v41, v9, s[96:99], s38 offen
    s_add_u32 s38, s39, 524288
    buffer_load_dword v42, v9, s[96:99], s38 offen
    s_add_u32 s38, s39, 786432
    buffer_load_dword v43, v9, s[96:99], s38 offen
    s_add_u32 s38, s39, 1048576
    buffer_load_dword v44, v9, s[96:99], s38 offen
    s_add_u32 s38, s39, 1310720
    buffer_load_dword v45, v9, s[96:99], s38 offen
    s_add_u32 s38, s39, 1572864
    buffer_load_dword v46, v9, s[96:99], s38 offen
    s_endpgm
.section .rodata,"a"
.p2align 6
.amdhsa_kernel ka_kernel
  .amdhsa_next_free_vgpr 192
  .amdhsa_next_free_sgpr 102
  .amdhsa_accum_offset 192
  .amdhsa_group_segment_fixed_size 0
  .amdhsa_kernarg_size 80
  .amdhsa_user_sgpr_count 2
  .amdhsa_user_sgpr_kernarg_segment_ptr 1
  .amdhsa_system_sgpr_workgroup_id_x 1
  .amdhsa_float_denorm_mode_32 3
  .amdhsa_float_denorm_mode_16_64 3
.end_amdhsa_kernel
.p2align 6
.amdhsa_kernel kb_kernel
  .amdhsa_next_free_vgpr 256
  .amdhsa_next_free_sgpr 102
  .amdhsa_accum_offset 256
  .amdhsa_group_segment_fixed_size 0
  .amdhsa_kernarg_size 80
  .amdhsa_user_sgpr_count 2
  .amdhsa_user_sgpr_kernarg_segment_ptr 1
  .amdhsa_system_sgpr_workgroup_id_x 1
  .amdhsa_float_denorm_mode_32 3
  .amdhsa_float_denorm_mode_16_64 3
.end_amdhsa_kernel
```
